```python
import torch

def _softmax(x, axis=-1):
    return torch.softmax(x, dim=axis)
def _gelu(x):
    return torch.nn.functional.gelu(x, approximate="tanh")
def _silu(x):
    return torch.nn.functional.silu(x)
def _sigmoid(x):
    return torch.sigmoid(x)
def _layernorm(x, axis=-1, eps=1e-5):
    m = x.mean(dim=axis, keepdim=True)
    v = x.var(dim=axis, keepdim=True, unbiased=False)
    return (x - m) / torch.sqrt(v + eps)
def _scatter_add(tgt, idx, src, axis=0):
    return tgt.clone().index_add_(axis, idx, src)
def _segment_sum(src, seg, n):
    out = torch.zeros((n,) + src.shape[1:], dtype=src.dtype)
    return out.index_add_(0, seg, src)
def _pad(x, pw):
    flat = tuple(v for pair in reversed(pw) for v in pair)
    return torch.nn.functional.pad(x, flat)

kernel_name = 'sequential_preLN__gqa_block_cached__glu_gated_glu__decode'

def setup_inputs():

    _w = (lambda a: (lambda t: t.to(torch.bfloat16) if t.is_floating_point() else t)(torch.as_tensor(a)))
    def _A_setup():
        B, Sq, D = 1, 1, 512
        Hq, Hkv, Sk, Dh = 32, 8, 65536, 128
        assert Hq % Hkv == 0, (Hq, Hkv)
        return {
            "x": _w((lambda *s: torch.randn(*s, dtype=torch.bfloat16) * 0.05)(B, Sq, D)),
            "k_cache": _w((lambda *s: torch.randn(*s, dtype=torch.bfloat16) * 3.2)(B, Hkv, Sk, Dh)),
            "v_cache": _w((lambda *s: torch.randn(*s, dtype=torch.bfloat16) * 0.4)(B, Hkv, Sk, Dh)),
            "wq": _w((lambda *s: torch.randn(*s, dtype=torch.bfloat16) * 3.2)(D, Hq * Dh) * (D ** -0.5)),
            "wo": _w((lambda *s: torch.randn(*s, dtype=torch.bfloat16) * 0.4)(Hq * Dh, D) * ((Hq * Dh) ** -0.5)),
        }
    _A_in = _A_setup()

    def _B_setup():
        B, S, D, F = 1, 1, 512, 1792
        return {
            "x": _w((lambda *s: torch.randn(*s, dtype=torch.bfloat16) * 0.05)(B, S, D)),
            "w_gate": _w((lambda *s: torch.randn(*s, dtype=torch.bfloat16) * 0.2)(D, F)),
            "w_up": _w((lambda *s: torch.randn(*s, dtype=torch.bfloat16) * 0.05)(D, F)),
            "w_down": _w((lambda *s: torch.randn(*s, dtype=torch.bfloat16) * 0.05)(F, D)),
        }
    _B_in = _B_setup()

    return {
        "A_x": _A_in["x"],
        "A_k_cache": _A_in["k_cache"],
        "A_v_cache": _A_in["v_cache"],
        "A_wq": _A_in["wq"],
        "A_wo": _A_in["wo"],
        "B_x": _B_in["x"],
        "B_w_gate": _B_in["w_gate"],
        "B_w_up": _B_in["w_up"],
        "B_w_down": _B_in["w_down"],
    }

def reference(A_x, A_k_cache, A_v_cache, A_wq, A_wo, B_x, B_w_gate, B_w_up, B_w_down):
    def _A_ref(x, k_cache, v_cache, wq, wo):
        B, Sq, D = x.shape
        Hq, Dh = 32, 128
        Hkv = k_cache.shape[1]
        rep = Hq // Hkv
        q = (lambda x, *d: x.permute(*d))((x @ wq).reshape(B, Sq, Hq, Dh), 0, 2, 1, 3)
        k = (lambda x, n, axis: torch.repeat_interleave(x, n, dim=axis))(k_cache, rep, axis=1)
        v = (lambda x, n, axis: torch.repeat_interleave(x, n, dim=axis))(v_cache, rep, axis=1)
        scores = torch.einsum("bhqd,bhkd->bhqk", q, k) * (Dh ** -0.5)
        p = _softmax(scores, axis=-1)
        o = torch.einsum("bhqk,bhkd->bhqd", p, v)
        return (lambda x, *d: x.permute(*d))(o, 0, 2, 1, 3).reshape(B, Sq, Hq * Dh) @ wo

    def _B_ref(x, w_gate, w_up, w_down):
        g = torch.einsum("bsd,df->bsf", x, w_gate)
        u = torch.einsum("bsd,df->bsf", x, w_up)
        h = _sigmoid(g) * u
        return torch.einsum("bsf,fd->bsd", h, w_down)

    x = A_x
    h = x + _A_ref(_layernorm(x, axis=-1), A_k_cache, A_v_cache, A_wq, A_wo)
    h2 = h + _B_ref(_layernorm(h, axis=-1), B_w_gate, B_w_up, B_w_down)
    return h2
```

```asm
; @launch grid=(256,1,1) block=(256,1,1) lds=22592
.amdgcn_target "amdgcn-amd-amdhsa--gfx950"
.text
.globl sequential_preLN__gqa_block_cached__glu_gated_glu__decode_kernel
.p2align 8
.type sequential_preLN__gqa_block_cached__glu_gated_glu__decode_kernel,@function
sequential_preLN__gqa_block_cached__glu_gated_glu__decode_kernel:
  s_cmp_ge_u32 s2, 256
  s_cbranch_scc1 L_end
  s_load_dwordx16 s[4:19], s[0:1], 0
  s_load_dwordx8 s[20:27], s[0:1], 64
  s_memrealtime s[96:97]
  v_lshrrev_b32 v2, 6, v0
  v_and_b32 v1, 63, v0
  s_mov_b32 s60, 0xffff0000
  v_readfirstlane_b32 s28, v2
  s_mov_b32 s61, 0x3db504f3
  s_mov_b32 s62, 0x3fb8aa3b
  s_mov_b32 s63, 0xbfb8aa3b
  s_lshr_b32 s33, s2, 3
  s_lshr_b32 s31, s33, 2
  s_and_b32 s33, s33, 3
  s_and_b32 s32, s2, 7
  s_lshl_b32 s32, s32, 2
  s_add_u32 s32, s32, s33
  s_and_b32 s34, s2, 7
  s_lshl_b32 s34, s34, 3
  s_add_u32 s3, s34, s31
  s_mov_b32 s70, 1
  s_bitcmp0_b32 s33, 0
  s_cbranch_scc1 L_role_done
  s_cmp_eq_u32 s33, 1
  s_cbranch_scc0 L_role_s3
  s_mov_b32 s70, 2
  s_cmp_lt_u32 s3, 56
  s_cbranch_scc1 L_role_done
  s_mov_b32 s70, 3
  s_sub_u32 s3, s3, 56
  s_branch L_role_done
L_role_s3:
  s_cmp_lt_u32 s3, 8
  s_cselect_b32 s70, 3, 0
  s_add_u32 s3, s3, 8
L_role_done:
  s_movk_i32 s49, 0x3ff
  v_lshlrev_b32 v3, 4, v1
  v_and_b32 v36, 3, v1
  v_lshlrev_b32 v36, 2, v36
  v_bfe_u32 v37, v1, 2, 2
  v_add_u32 v36, v36, v37
  v_lshlrev_b32 v36, 8, v36
  v_lshrrev_b32 v37, 4, v1
  v_lshl_add_u32 v2, v37, 4, v36
  v_mov_b32 v50, 0
  v_lshlrev_b32 v43, 5, v1
  v_lshrrev_b32 v48, 4, v1
  v_lshlrev_b32 v48, 9, v48
  v_and_b32 v49, 15, v1
  v_lshl_add_u32 v48, v49, 3, v48
  s_mov_b32 s72, 0
  v_mov_b32 v124, 0
  v_mov_b32 v125, 0
  s_mov_b32 s73, 0
  s_waitcnt lgkmcnt(0)
  s_load_dword s29, s[26:27], 0
  s_mov_b32 s44, s26
  s_mov_b32 s45, s27
  s_mov_b32 s46, 2097152
  s_mov_b32 s47, 0x00020000
  s_mov_b32 s56, s4
  s_mov_b32 s57, s5
  s_mov_b32 s58, 1024
  s_mov_b32 s59, 0x00020000
  buffer_load_dwordx4 v[136:139], v3, s[56:59], 0 offen
  s_and_b32 s33, s2, 7
  s_lshl_b32 s33, s33, 5
  s_lshr_b32 s34, s2, 3
  s_add_u32 s84, s33, s34
  s_and_b32 s33, s34, 3
  s_lshl_b32 s33, s33, 2
  s_add_u32 s33, s33, s28
  s_lshl_b32 s35, s33, 6
  v_lshrrev_b32 v36, 3, v1
  v_lshl_add_u32 v37, v36, 3, s35
  buffer_load_dwordx2 v[140:141], v37, s[56:59], 0 offen
  s_lshl_b32 s33, s33, 18
  s_lshr_b32 s34, s84, 2
  s_lshl_b32 s34, s34, 7
  s_add_u32 s34, s34, s33
  s_add_u32 s52, s10, s34
  s_addc_u32 s53, s11, 0
  s_mov_b32 s54, 254080
  s_mov_b32 s55, 0x00020000
  v_lshlrev_b32 v36, 15, v36
  v_and_b32 v37, 7, v1
  v_lshl_add_u32 v36, v37, 4, v36
  s_mov_b32 s35, 0
  buffer_load_dwordx4 v[120:123], v36, s[52:55], s35 offen nt
  s_mov_b32 s35, 8192
  buffer_load_dwordx4 v[124:127], v36, s[52:55], s35 offen nt
  s_mov_b32 s35, 16384
  buffer_load_dwordx4 v[128:131], v36, s[52:55], s35 offen nt
  s_mov_b32 s35, 24576
  buffer_load_dwordx4 v[132:135], v36, s[52:55], s35 offen nt
  s_lshl_b32 s33, s31, 24
  s_add_u32 s36, s6, s33
  s_addc_u32 s37, s7, 0
  s_mov_b32 s38, 16777216
  s_mov_b32 s39, 0x00020000
  s_add_u32 s40, s8, s33
  s_addc_u32 s41, s9, 0
  s_mov_b32 s42, 16777216
  s_mov_b32 s43, 0x00020000
  s_mul_i32 s81, s32, 425984
  s_mov_b32 s89, s96
  s_mov_b32 s87, 0
  s_mov_b32 s50, 0
  s_mov_b32 s88, 0
  v_mov_b32 v37, -1
  ds_write_b32 v50, v37 offset:22540
  s_lshr_b32 s81, s32, 2
  s_mul_i32 s81, s81, 1703936
  s_and_b32 s34, s32, 3
  s_lshl_b32 s34, s34, 15
  s_add_u32 s81, s81, s34
  s_mov_b32 s94, s28
  s_mov_b32 s33, s94
  s_lshr_b32 s34, s33, 3
  s_lshl_b32 s34, s34, 17
  s_and_b32 s35, s33, 7
  s_lshl_b32 s35, s35, 12
  s_add_u32 s34, s34, s35
  s_add_u32 s34, s34, s81
  s_mov_b32 s64, s34
  v_mov_b32 v45, 1
  v_mov_b32 v36, 32
  ds_write_b32 v50, v36 offset:22528
  ds_write_b32 v50, v50 offset:22544
  s_waitcnt lgkmcnt(0)
  s_barrier
  buffer_load_dwordx4 v[56:59], v2, s[36:39], s64 offen offset:0 nt
  buffer_load_dwordx4 v[60:63], v2, s[36:39], s64 offen offset:64 nt
  buffer_load_dwordx4 v[64:67], v2, s[36:39], s64 offen offset:128 nt
  buffer_load_dwordx4 v[68:71], v2, s[36:39], s64 offen offset:192 nt
  buffer_load_dwordx4 v[72:75], v3, s[40:43], s64 offen offset:0 nt
  buffer_load_dwordx4 v[76:79], v3, s[40:43], s64 offen offset:1024 nt
  buffer_load_dwordx4 v[80:83], v3, s[40:43], s64 offen offset:2048 nt
  buffer_load_dwordx4 v[84:87], v3, s[40:43], s64 offen offset:3072 nt
  s_add_u32 s94, s94, 4
  s_mov_b32 s33, s94
  s_lshr_b32 s34, s33, 3
  s_lshl_b32 s34, s34, 17
  s_and_b32 s35, s33, 7
  s_lshl_b32 s35, s35, 12
  s_add_u32 s34, s34, s35
  s_add_u32 s34, s34, s81
  s_mov_b32 s64, s34
  buffer_load_dwordx4 v[88:91], v2, s[36:39], s64 offen offset:0 nt
  buffer_load_dwordx4 v[92:95], v2, s[36:39], s64 offen offset:64 nt
  buffer_load_dwordx4 v[96:99], v2, s[36:39], s64 offen offset:128 nt
  buffer_load_dwordx4 v[100:103], v2, s[36:39], s64 offen offset:192 nt
  s_mov_b32 s82, 0
  s_waitcnt vmcnt(16)
  v_lshlrev_b32 v4, 16, v136
  v_and_b32 v5, s60, v136
  v_lshlrev_b32 v6, 16, v137
  v_and_b32 v7, s60, v137
  v_lshlrev_b32 v8, 16, v138
  v_and_b32 v9, s60, v138
  v_lshlrev_b32 v10, 16, v139
  v_and_b32 v11, s60, v139
  v_lshlrev_b32 v12, 16, v140
  v_and_b32 v13, s60, v140
  v_lshlrev_b32 v14, 16, v141
  v_and_b32 v15, s60, v141
  v_add_f32 v32, v4, v5
  v_add_f32 v32, v32, v6
  v_add_f32 v32, v32, v7
  v_add_f32 v32, v32, v8
  v_add_f32 v32, v32, v9
  v_add_f32 v32, v32, v10
  v_add_f32 v32, v32, v11
  s_nop 1
  v_add_f32_dpp v32, v32, v32 quad_perm:[1,0,3,2] row_mask:0xf bank_mask:0xf
  s_nop 1
  v_add_f32_dpp v32, v32, v32 quad_perm:[2,3,0,1] row_mask:0xf bank_mask:0xf
  s_nop 1
  v_add_f32_dpp v32, v32, v32 row_half_mirror row_mask:0xf bank_mask:0xf
  s_nop 1
  v_add_f32_dpp v32, v32, v32 row_mirror row_mask:0xf bank_mask:0xf
  v_mov_b32 v33, v32
  s_nop 1
  v_permlane32_swap_b32 v32, v33
  s_nop 0
  v_add_f32 v32, v32, v33
  v_mov_b32 v33, v32
  s_nop 1
  v_permlane16_swap_b32 v32, v33
  s_nop 0
  v_add_f32 v32, v32, v33
  v_mul_f32 v32, 0x3b000000, v32
  v_sub_f32 v33, v4, v32
  v_mul_f32 v34, v33, v33
  v_sub_f32 v33, v5, v32
  v_fmac_f32 v34, v33, v33
  v_sub_f32 v33, v6, v32
  v_fmac_f32 v34, v33, v33
  v_sub_f32 v33, v7, v32
  v_fmac_f32 v34, v33, v33
  v_sub_f32 v33, v8, v32
  v_fmac_f32 v34, v33, v33
  v_sub_f32 v33, v9, v32
  v_fmac_f32 v34, v33, v33
  v_sub_f32 v33, v10, v32
  v_fmac_f32 v34, v33, v33
  v_sub_f32 v33, v11, v32
  v_fmac_f32 v34, v33, v33
  s_nop 1
  v_add_f32_dpp v34, v34, v34 quad_perm:[1,0,3,2] row_mask:0xf bank_mask:0xf
  s_nop 1
  v_add_f32_dpp v34, v34, v34 quad_perm:[2,3,0,1] row_mask:0xf bank_mask:0xf
  s_nop 1
  v_add_f32_dpp v34, v34, v34 row_half_mirror row_mask:0xf bank_mask:0xf
  s_nop 1
  v_add_f32_dpp v34, v34, v34 row_mirror row_mask:0xf bank_mask:0xf
  v_mov_b32 v33, v34
  s_nop 1
  v_permlane32_swap_b32 v34, v33
  s_nop 0
  v_add_f32 v34, v34, v33
  v_mov_b32 v33, v34
  s_nop 1
  v_permlane16_swap_b32 v34, v33
  s_nop 0
  v_add_f32 v34, v34, v33
  v_mul_f32 v34, 0x3b000000, v34
  v_cvt_pk_bf16_f32 v32, v32, v32
  v_and_b32 v32, s60, v32
  v_cvt_pk_bf16_f32 v34, v34, v34
  v_and_b32 v34, s60, v34
  v_add_f32 v34, 0x3727c5ac, v34
  v_cvt_pk_bf16_f32 v34, v34, v34
  v_and_b32 v34, s60, v34
  v_sqrt_f32 v34, v34
  s_nop 0
  v_cvt_pk_bf16_f32 v34, v34, v34
  v_and_b32 v34, s60, v34
  v_rcp_f32 v35, v34
  v_sub_f32 v12, v12, v32
  v_sub_f32 v13, v13, v32
  v_sub_f32 v14, v14, v32
  v_sub_f32 v15, v15, v32
  v_cvt_pk_bf16_f32 v33, v12, v13
  v_lshlrev_b32 v12, 16, v33
  v_and_b32 v13, s60, v33
  v_cvt_pk_bf16_f32 v33, v14, v15
  v_lshlrev_b32 v14, 16, v33
  v_and_b32 v15, s60, v33
  v_mul_f32 v33, v12, v35
  v_fma_f32 v12, -v33, v34, v12
  v_fma_f32 v12, v12, v35, v33
  v_mul_f32 v33, v13, v35
  v_fma_f32 v13, -v33, v34, v13
  v_fma_f32 v13, v13, v35, v33
  v_mul_f32 v33, v14, v35
  v_fma_f32 v14, -v33, v34, v14
  v_fma_f32 v14, v14, v35, v33
  v_mul_f32 v33, v15, v35
  v_fma_f32 v15, -v33, v34, v15
  v_fma_f32 v15, v15, v35, v33
  v_cvt_pk_bf16_f32 v33, v12, v13
  v_lshlrev_b32 v12, 16, v33
  v_and_b32 v13, s60, v33
  v_cvt_pk_bf16_f32 v33, v14, v15
  v_lshlrev_b32 v14, 16, v33
  v_and_b32 v15, s60, v33
  s_waitcnt vmcnt(15)
  v_lshlrev_b32 v38, 16, v120
  v_and_b32 v39, s60, v120
  v_mul_f32 v16, v12, v38
  v_mul_f32 v17, v12, v39
  v_lshlrev_b32 v38, 16, v121
  v_and_b32 v39, s60, v121
  v_mul_f32 v18, v12, v38
  v_mul_f32 v19, v12, v39
  v_lshlrev_b32 v38, 16, v122
  v_and_b32 v39, s60, v122
  v_mul_f32 v20, v12, v38
  v_mul_f32 v21, v12, v39
  v_lshlrev_b32 v38, 16, v123
  v_and_b32 v39, s60, v123
  v_mul_f32 v22, v12, v38
  v_mul_f32 v23, v12, v39
  s_waitcnt vmcnt(14)
  v_lshlrev_b32 v38, 16, v124
  v_and_b32 v39, s60, v124
  v_fmac_f32 v16, v13, v38
  v_fmac_f32 v17, v13, v39
  v_lshlrev_b32 v38, 16, v125
  v_and_b32 v39, s60, v125
  v_fmac_f32 v18, v13, v38
  v_fmac_f32 v19, v13, v39
  v_lshlrev_b32 v38, 16, v126
  v_and_b32 v39, s60, v126
  v_fmac_f32 v20, v13, v38
  v_fmac_f32 v21, v13, v39
  v_lshlrev_b32 v38, 16, v127
  v_and_b32 v39, s60, v127
  v_fmac_f32 v22, v13, v38
  v_fmac_f32 v23, v13, v39
  s_waitcnt vmcnt(13)
  v_lshlrev_b32 v38, 16, v128
  v_and_b32 v39, s60, v128
  v_fmac_f32 v16, v14, v38
  v_fmac_f32 v17, v14, v39
  v_lshlrev_b32 v38, 16, v129
  v_and_b32 v39, s60, v129
  v_fmac_f32 v18, v14, v38
  v_fmac_f32 v19, v14, v39
  v_lshlrev_b32 v38, 16, v130
  v_and_b32 v39, s60, v130
  v_fmac_f32 v20, v14, v38
  v_fmac_f32 v21, v14, v39
  v_lshlrev_b32 v38, 16, v131
  v_and_b32 v39, s60, v131
  v_fmac_f32 v22, v14, v38
  v_fmac_f32 v23, v14, v39
  s_waitcnt vmcnt(12)
  v_lshlrev_b32 v38, 16, v132
  v_and_b32 v39, s60, v132
  v_fmac_f32 v16, v15, v38
  v_fmac_f32 v17, v15, v39
  v_lshlrev_b32 v38, 16, v133
  v_and_b32 v39, s60, v133
  v_fmac_f32 v18, v15, v38
  v_fmac_f32 v19, v15, v39
  v_lshlrev_b32 v38, 16, v134
  v_and_b32 v39, s60, v134
  v_fmac_f32 v20, v15, v38
  v_fmac_f32 v21, v15, v39
  v_lshlrev_b32 v38, 16, v135
  v_and_b32 v39, s60, v135
  v_fmac_f32 v22, v15, v38
  v_fmac_f32 v23, v15, v39
  s_nop 1
  v_permlane32_swap_b32 v16, v20
  v_permlane32_swap_b32 v17, v21
  v_permlane32_swap_b32 v18, v22
  v_permlane32_swap_b32 v19, v23
  s_nop 0
  v_add_f32 v16, v16, v20
  v_add_f32 v17, v17, v21
  v_add_f32 v18, v18, v22
  v_add_f32 v19, v19, v23
  s_nop 1
  v_permlane16_swap_b32 v16, v18
  v_permlane16_swap_b32 v17, v19
  s_nop 0
  v_add_f32 v16, v16, v18
  v_add_f32 v17, v17, v19
  s_lshl_b32 s35, s28, 8
  v_and_b32 v32, 7, v1
  v_add_f32_dpp v16, v16, v16 row_ror:8 row_mask:0xf bank_mask:0xf
  v_add_f32_dpp v17, v17, v17 row_ror:8 row_mask:0xf bank_mask:0xf
  v_lshlrev_b32 v32, 5, v32
  v_lshrrev_b32 v33, 4, v1
  v_lshl_add_u32 v32, v33, 3, v32
  v_add_u32 v32, s35, v32
  s_mov_b32 exec_lo, 0xff00ff
  s_mov_b32 exec_hi, 0xff00ff
  ds_write_b64 v32, v[16:17] offset:21504
  s_mov_b64 exec, -1
  s_waitcnt lgkmcnt(0)
  s_mul_i32 s30, s29, 0x9e3779b1
  s_add_u32 s30, s30, 0x7f4a7c15
  s_add_u32 s71, s29, 1
  s_and_b32 s71, s71, s49
  s_barrier
  s_cmp_lg_u32 s28, 0
  s_cbranch_scc1 nopub_1
  v_lshlrev_b32 v36, 2, v1
  ds_read_b32 v4, v36 offset:21504
  ds_read_b32 v6, v36 offset:21760
  ds_read_b32 v8, v36 offset:22016
  ds_read_b32 v10, v36 offset:22272
  v_lshlrev_b32 v36, 3, v1
  s_lshl_b32 s33, s84, 9
  s_add_u32 s33, s33, 786432
  v_mov_b32 v5, s30
  s_waitcnt lgkmcnt(0)
  v_add_f32 v4, v4, v6
  v_add_f32 v8, v8, v10
  v_add_f32 v4, v4, v8
  buffer_store_dwordx2 v[4:5], v36, s[44:47], s33 offen sc1
  s_and_b32 s73, s32, 3
  s_lshl_b32 s73, s73, 14
  s_lshl_b32 s33, s31, 11
  s_add_u32 s73, s73, s33
  s_add_u32 s73, s73, 65536
  s_and_b32 s72, s84, -4
  s_lshl_b32 s72, s72, 9
  s_and_b32 s33, s84, 3
  s_lshl_b32 s33, s33, 7
  s_add_u32 s72, s72, s33
  s_add_u32 s72, s72, 786432
nopub_1:
  s_waitcnt vmcnt(8)
  buffer_load_dwordx4 v[104:107], v3, s[40:43], s64 offen offset:0 nt
  buffer_load_dwordx4 v[108:111], v3, s[40:43], s64 offen offset:1024 nt
  buffer_load_dwordx4 v[112:115], v3, s[40:43], s64 offen offset:2048 nt
  buffer_load_dwordx4 v[116:119], v3, s[40:43], s64 offen offset:3072 nt
  s_add_u32 s94, s94, 4
  s_mov_b32 s33, s94
  s_lshr_b32 s34, s33, 3
  s_lshl_b32 s34, s34, 17
  s_and_b32 s35, s33, 7
  s_lshl_b32 s35, s35, 12
  s_add_u32 s34, s34, s35
  s_add_u32 s34, s34, s81
  s_mov_b32 s64, s34
  s_waitcnt vmcnt(8)
  buffer_load_dwordx4 a[0:3], v2, s[36:39], s64 offen offset:0 nt
  buffer_load_dwordx4 a[4:7], v2, s[36:39], s64 offen offset:64 nt
  buffer_load_dwordx4 a[8:11], v2, s[36:39], s64 offen offset:128 nt
  buffer_load_dwordx4 a[12:15], v2, s[36:39], s64 offen offset:192 nt
  s_cmp_lg_u32 s28, 0
  s_cbranch_scc1 qp_skip_2
  buffer_load_dwordx2 v[8:9], v48, s[44:47], s72 offen sc1
qp_skip_2:
  s_waitcnt vmcnt(8)
  buffer_load_dwordx4 a[16:19], v3, s[40:43], s64 offen offset:0 nt
  buffer_load_dwordx4 a[20:23], v3, s[40:43], s64 offen offset:1024 nt
  buffer_load_dwordx4 a[24:27], v3, s[40:43], s64 offen offset:2048 nt
  buffer_load_dwordx4 a[28:31], v3, s[40:43], s64 offen offset:3072 nt
  s_add_u32 s94, s94, 4
  s_mov_b32 s33, s94
  s_lshr_b32 s34, s33, 3
  s_lshl_b32 s34, s34, 17
  s_and_b32 s35, s33, 7
  s_lshl_b32 s35, s35, 12
  s_add_u32 s34, s34, s35
  s_add_u32 s34, s34, s81
  s_mov_b32 s64, s34
  s_waitcnt vmcnt(8)
  buffer_load_dwordx4 a[32:35], v2, s[36:39], s64 offen offset:0 nt
  buffer_load_dwordx4 a[36:39], v2, s[36:39], s64 offen offset:64 nt
  buffer_load_dwordx4 a[40:43], v2, s[36:39], s64 offen offset:128 nt
  buffer_load_dwordx4 a[44:47], v2, s[36:39], s64 offen offset:192 nt
  s_waitcnt vmcnt(8)
  buffer_load_dwordx4 a[48:51], v3, s[40:43], s64 offen offset:0 nt
  buffer_load_dwordx4 a[52:55], v3, s[40:43], s64 offen offset:1024 nt
  buffer_load_dwordx4 a[56:59], v3, s[40:43], s64 offen offset:2048 nt
  buffer_load_dwordx4 a[60:63], v3, s[40:43], s64 offen offset:3072 nt
  s_add_u32 s94, s94, 4
  s_mov_b32 s33, s94
  s_lshr_b32 s34, s33, 3
  s_lshl_b32 s34, s34, 17
  s_and_b32 s35, s33, 7
  s_lshl_b32 s35, s35, 12
  s_add_u32 s34, s34, s35
  s_add_u32 s34, s34, s81
  s_mov_b32 s64, s34
  s_cmp_lg_u32 s28, 0
  s_cbranch_scc1 qp_skip_6
  s_cmp_eq_u32 s82, 2
  s_cbranch_scc1 qp_skip_6
  s_cmp_eq_u32 s82, 1
  s_cbranch_scc1 qp_st1_7
  v_cmp_ne_u32 vcc, s30, v9
  s_nop 0
  s_cbranch_vccnz qp_a0_8
  v_mov_b32 v37, v8
  s_nop 1
  v_permlane32_swap_b32 v8, v37
  s_nop 0
  v_add_f32 v8, v8, v37
  v_mov_b32 v37, v8
  s_nop 1
  v_permlane16_swap_b32 v8, v37
  s_nop 0
  v_add_f32 v8, v8, v37
  v_and_b32 v36, 15, v1
  v_lshlrev_b32 v36, 2, v36
  v_mov_b32_dpp v37, v8 quad_perm:[1,0,3,2] row_mask:0xf bank_mask:0xf
  v_lshrrev_b32 v10, 4, v1
  v_lshl_add_u32 v36, v10, 14, v36
  v_cvt_pk_bf16_f32 v8, v8, v37
  s_lshl_b32 s33, s84, 6
  s_add_u32 s33, s33, 65536
  s_mov_b32 exec_lo, 0x55555555
  s_mov_b32 exec_hi, 0x55555555
  buffer_store_dwordx2 v[8:9], v36, s[44:47], s33 offen sc1
  s_mov_b64 exec, -1
  s_mov_b32 s82, 1
  s_branch qp_a1_9
qp_a0_8:
  buffer_load_dwordx2 v[8:9], v48, s[44:47], s72 offen sc1
  s_branch qp_skip_6
qp_st1_7:
  v_xor_b32 v36, s30, v13
  v_xor_b32 v37, s30, v15
  v_or_b32 v36, v36, v37
  v_xor_b32 v37, s30, v17
  v_or_b32 v36, v36, v37
  v_xor_b32 v37, s30, v19
  v_or_b32 v36, v36, v37
  v_cmp_ne_u32 vcc, 0, v36
  s_nop 0
  s_cbranch_vccnz qp_a1_9
  v_mov_b32 v13, v14
  v_mov_b32 v14, v16
  v_mov_b32 v15, v18
  ds_write_b128 v3, v[12:15] offset:0
  ds_write_b32 v50, v45 offset:22544
  s_mov_b32 s82, 2
  s_branch qp_skip_6
qp_a1_9:
  buffer_load_dwordx4 v[12:15], v43, s[44:47], s73 offen sc1
  buffer_load_dwordx4 v[16:19], v43, s[44:47], s73 offen offset:16 sc1
qp_skip_6:
  s_waitcnt vmcnt(8)
  buffer_load_dwordx4 a[64:67], v2, s[36:39], s64 offen offset:0 nt
  buffer_load_dwordx4 a[68:71], v2, s[36:39], s64 offen offset:64 nt
  buffer_load_dwordx4 a[72:75], v2, s[36:39], s64 offen offset:128 nt
  buffer_load_dwordx4 a[76:79], v2, s[36:39], s64 offen offset:192 nt
  s_waitcnt vmcnt(8)
  buffer_load_dwordx4 a[80:83], v3, s[40:43], s64 offen offset:0 nt
  buffer_load_dwordx4 a[84:87], v3, s[40:43], s64 offen offset:1024 nt
  buffer_load_dwordx4 a[88:91], v3, s[40:43], s64 offen offset:2048 nt
  buffer_load_dwordx4 a[92:95], v3, s[40:43], s64 offen offset:3072 nt
  s_add_u32 s94, s94, 4
  s_mov_b32 s33, s94
  s_lshr_b32 s34, s33, 3
  s_lshl_b32 s34, s34, 17
  s_and_b32 s35, s33, 7
  s_lshl_b32 s35, s35, 12
  s_add_u32 s34, s34, s35
  s_add_u32 s34, s34, s81
  s_mov_b32 s64, s34
  s_waitcnt vmcnt(8)
  buffer_load_dwordx4 a[96:99], v2, s[36:39], s64 offen offset:0 nt
  buffer_load_dwordx4 a[100:103], v2, s[36:39], s64 offen offset:64 nt
  buffer_load_dwordx4 a[104:107], v2, s[36:39], s64 offen offset:128 nt
  buffer_load_dwordx4 a[108:111], v2, s[36:39], s64 offen offset:192 nt
  s_cmp_lg_u32 s28, 0
  s_cbranch_scc1 qp_skip_10
  s_cmp_eq_u32 s82, 2
  s_cbranch_scc1 qp_skip_10
  s_cmp_eq_u32 s82, 1
  s_cbranch_scc1 qp_st1_11
  v_cmp_ne_u32 vcc, s30, v9
  s_nop 0
  s_cbranch_vccnz qp_a0_12
  v_mov_b32 v37, v8
  s_nop 1
  v_permlane32_swap_b32 v8, v37
  s_nop 0
  v_add_f32 v8, v8, v37
  v_mov_b32 v37, v8
  s_nop 1
  v_permlane16_swap_b32 v8, v37
  s_nop 0
  v_add_f32 v8, v8, v37
  v_and_b32 v36, 15, v1
  v_lshlrev_b32 v36, 2, v36
  v_mov_b32_dpp v37, v8 quad_perm:[1,0,3,2] row_mask:0xf bank_mask:0xf
  v_lshrrev_b32 v10, 4, v1
  v_lshl_add_u32 v36, v10, 14, v36
  v_cvt_pk_bf16_f32 v8, v8, v37
  s_lshl_b32 s33, s84, 6
  s_add_u32 s33, s33, 65536
  s_mov_b32 exec_lo, 0x55555555
  s_mov_b32 exec_hi, 0x55555555
  buffer_store_dwordx2 v[8:9], v36, s[44:47], s33 offen sc1
  s_mov_b64 exec, -1
  s_mov_b32 s82, 1
  s_branch qp_a1_13
qp_a0_12:
  buffer_load_dwordx2 v[8:9], v48, s[44:47], s72 offen sc1
  s_branch qp_skip_10
qp_st1_11:
  v_xor_b32 v36, s30, v13
  v_xor_b32 v37, s30, v15
  v_or_b32 v36, v36, v37
  v_xor_b32 v37, s30, v17
  v_or_b32 v36, v36, v37
  v_xor_b32 v37, s30, v19
  v_or_b32 v36, v36, v37
  v_cmp_ne_u32 vcc, 0, v36
  s_nop 0
  s_cbranch_vccnz qp_a1_13
  v_mov_b32 v13, v14
  v_mov_b32 v14, v16
  v_mov_b32 v15, v18
  ds_write_b128 v3, v[12:15] offset:0
  ds_write_b32 v50, v45 offset:22544
  s_mov_b32 s82, 2
  s_branch qp_skip_10
qp_a1_13:
  buffer_load_dwordx4 v[12:15], v43, s[44:47], s73 offen sc1
  buffer_load_dwordx4 v[16:19], v43, s[44:47], s73 offen offset:16 sc1
qp_skip_10:
  s_waitcnt vmcnt(8)
  buffer_load_dwordx4 a[112:115], v3, s[40:43], s64 offen offset:0 nt
  buffer_load_dwordx4 a[116:119], v3, s[40:43], s64 offen offset:1024 nt
  buffer_load_dwordx4 a[120:123], v3, s[40:43], s64 offen offset:2048 nt
  buffer_load_dwordx4 a[124:127], v3, s[40:43], s64 offen offset:3072 nt
  s_add_u32 s94, s94, 4
  s_mov_b32 s33, s94
  s_lshr_b32 s34, s33, 3
  s_lshl_b32 s34, s34, 17
  s_and_b32 s35, s33, 7
  s_lshl_b32 s35, s35, 12
  s_add_u32 s34, s34, s35
  s_add_u32 s34, s34, s81
  s_mov_b32 s64, s34
  s_waitcnt vmcnt(8)
  buffer_load_dwordx4 a[128:131], v2, s[36:39], s64 offen offset:0 nt
  buffer_load_dwordx4 a[132:135], v2, s[36:39], s64 offen offset:64 nt
  buffer_load_dwordx4 a[136:139], v2, s[36:39], s64 offen offset:128 nt
  buffer_load_dwordx4 a[140:143], v2, s[36:39], s64 offen offset:192 nt
  s_waitcnt vmcnt(8)
  buffer_load_dwordx4 a[144:147], v3, s[40:43], s64 offen offset:0 nt
  buffer_load_dwordx4 a[148:151], v3, s[40:43], s64 offen offset:1024 nt
  buffer_load_dwordx4 a[152:155], v3, s[40:43], s64 offen offset:2048 nt
  buffer_load_dwordx4 a[156:159], v3, s[40:43], s64 offen offset:3072 nt
  s_add_u32 s94, s94, 4
  s_mov_b32 s33, s94
  s_lshr_b32 s34, s33, 3
  s_lshl_b32 s34, s34, 17
  s_and_b32 s35, s33, 7
  s_lshl_b32 s35, s35, 12
  s_add_u32 s34, s34, s35
  s_add_u32 s34, s34, s81
  s_mov_b32 s64, s34
  s_cmp_lg_u32 s28, 0
  s_cbranch_scc1 qp_skip_14
  s_cmp_eq_u32 s82, 2
  s_cbranch_scc1 qp_skip_14
  s_cmp_eq_u32 s82, 1
  s_cbranch_scc1 qp_st1_15
  v_cmp_ne_u32 vcc, s30, v9
  s_nop 0
  s_cbranch_vccnz qp_a0_16
  v_mov_b32 v37, v8
  s_nop 1
  v_permlane32_swap_b32 v8, v37
  s_nop 0
  v_add_f32 v8, v8, v37
  v_mov_b32 v37, v8
  s_nop 1
  v_permlane16_swap_b32 v8, v37
  s_nop 0
  v_add_f32 v8, v8, v37
  v_and_b32 v36, 15, v1
  v_lshlrev_b32 v36, 2, v36
  v_mov_b32_dpp v37, v8 quad_perm:[1,0,3,2] row_mask:0xf bank_mask:0xf
  v_lshrrev_b32 v10, 4, v1
  v_lshl_add_u32 v36, v10, 14, v36
  v_cvt_pk_bf16_f32 v8, v8, v37
  s_lshl_b32 s33, s84, 6
  s_add_u32 s33, s33, 65536
  s_mov_b32 exec_lo, 0x55555555
  s_mov_b32 exec_hi, 0x55555555
  buffer_store_dwordx2 v[8:9], v36, s[44:47], s33 offen sc1
  s_mov_b64 exec, -1
  s_mov_b32 s82, 1
  s_branch qp_a1_17
qp_a0_16:
  buffer_load_dwordx2 v[8:9], v48, s[44:47], s72 offen sc1
  s_branch qp_skip_14
qp_st1_15:
  v_xor_b32 v36, s30, v13
  v_xor_b32 v37, s30, v15
  v_or_b32 v36, v36, v37
  v_xor_b32 v37, s30, v17
  v_or_b32 v36, v36, v37
  v_xor_b32 v37, s30, v19
  v_or_b32 v36, v36, v37
  v_cmp_ne_u32 vcc, 0, v36
  s_nop 0
  s_cbranch_vccnz qp_a1_17
  v_mov_b32 v13, v14
  v_mov_b32 v14, v16
  v_mov_b32 v15, v18
  ds_write_b128 v3, v[12:15] offset:0
  ds_write_b32 v50, v45 offset:22544
  s_mov_b32 s82, 2
  s_branch qp_skip_14
qp_a1_17:
  buffer_load_dwordx4 v[12:15], v43, s[44:47], s73 offen sc1
  buffer_load_dwordx4 v[16:19], v43, s[44:47], s73 offen offset:16 sc1
qp_skip_14:
  s_waitcnt vmcnt(8)
  buffer_load_dwordx4 a[160:163], v2, s[36:39], s64 offen offset:0 nt
  buffer_load_dwordx4 a[164:167], v2, s[36:39], s64 offen offset:64 nt
  buffer_load_dwordx4 a[168:171], v2, s[36:39], s64 offen offset:128 nt
  buffer_load_dwordx4 a[172:175], v2, s[36:39], s64 offen offset:192 nt
  s_waitcnt vmcnt(8)
  buffer_load_dwordx4 a[176:179], v3, s[40:43], s64 offen offset:0 nt
  buffer_load_dwordx4 a[180:183], v3, s[40:43], s64 offen offset:1024 nt
  buffer_load_dwordx4 a[184:187], v3, s[40:43], s64 offen offset:2048 nt
  buffer_load_dwordx4 a[188:191], v3, s[40:43], s64 offen offset:3072 nt
  s_add_u32 s94, s94, 4
  s_mov_b32 s33, s94
  s_lshr_b32 s34, s33, 3
  s_lshl_b32 s34, s34, 17
  s_and_b32 s35, s33, 7
  s_lshl_b32 s35, s35, 12
  s_add_u32 s34, s34, s35
  s_add_u32 s34, s34, s81
  s_mov_b32 s64, s34
  v_and_b32 v36, 3, v1
  v_mov_b32 v34, 0
  v_mov_b32 v35, 0
  v_mov_b32 v37, 0xffff
  v_mov_b32 v42, s60
  v_cmp_eq_u32 vcc, 0, v36
  s_nop 1
  v_cndmask_b32 v34, v34, v37, vcc
  v_cmp_eq_u32 vcc, 1, v36
  s_nop 1
  v_cndmask_b32 v34, v34, v42, vcc
  v_cmp_eq_u32 vcc, 2, v36
  s_nop 1
  v_cndmask_b32 v35, v35, v37, vcc
  v_cmp_eq_u32 vcc, 3, v36
  s_nop 1
  v_cndmask_b32 v35, v35, v42, vcc
  v_mov_b32 v24, 0
  v_mov_b32 v25, 0
  v_mov_b32 v26, 0
  v_mov_b32 v27, 0
  v_mov_b32 v28, 0
  v_mov_b32 v29, 0
  v_mov_b32 v30, 0
  v_mov_b32 v31, 0
  v_mov_b32 v54, s71
  v_bfe_u32 v36, v1, 2, 2
  v_lshlrev_b32 v36, 9, v36
  v_lshrrev_b32 v37, 4, v1
  v_lshl_add_u32 v36, v37, 6, v36
  v_and_b32 v37, 3, v1
  v_lshl_add_u32 v55, v37, 4, v36
  v_mov_b32 v32, 0xff800000
  v_mov_b32 v33, 0
  s_mov_b32 s77, 1
  s_mov_b32 s78, 1
  s_mov_b32 s83, 1
  s_cmp_lg_u32 s28, 0
  s_cbranch_scc1 qf_skip_18
  s_mov_b32 s68, 200000
qf_loop_19:
  s_cmp_eq_u32 s82, 2
  s_cbranch_scc1 qf_skip_18
  s_waitcnt vmcnt(0)
  s_cmp_eq_u32 s82, 1
  s_cbranch_scc1 qf_st1_20
  v_cmp_ne_u32 vcc, s30, v9
  s_nop 0
  s_cbranch_vccnz qf_a0_21
  v_mov_b32 v37, v8
  s_nop 1
  v_permlane32_swap_b32 v8, v37
  s_nop 0
  v_add_f32 v8, v8, v37
  v_mov_b32 v37, v8
  s_nop 1
  v_permlane16_swap_b32 v8, v37
  s_nop 0
  v_add_f32 v8, v8, v37
  v_and_b32 v36, 15, v1
  v_lshlrev_b32 v36, 2, v36
  v_mov_b32_dpp v37, v8 quad_perm:[1,0,3,2] row_mask:0xf bank_mask:0xf
  v_lshrrev_b32 v10, 4, v1
  v_lshl_add_u32 v36, v10, 14, v36
  v_cvt_pk_bf16_f32 v8, v8, v37
  s_lshl_b32 s33, s84, 6
  s_add_u32 s33, s33, 65536
  s_mov_b32 exec_lo, 0x55555555
  s_mov_b32 exec_hi, 0x55555555
  buffer_store_dwordx2 v[8:9], v36, s[44:47], s33 offen sc1
  s_mov_b64 exec, -1
  s_mov_b32 s82, 1
  s_branch qf_a1_22
qf_a0_21:
  buffer_load_dwordx2 v[8:9], v48, s[44:47], s72 offen sc1
  s_branch qf_nx_23
qf_st1_20:
  v_xor_b32 v36, s30, v13
  v_xor_b32 v37, s30, v15
  v_or_b32 v36, v36, v37
  v_xor_b32 v37, s30, v17
  v_or_b32 v36, v36, v37
  v_xor_b32 v37, s30, v19
  v_or_b32 v36, v36, v37
  v_cmp_ne_u32 vcc, 0, v36
  s_nop 0
  s_cbranch_vccnz qf_a1_22
  v_mov_b32 v13, v14
  v_mov_b32 v14, v16
  v_mov_b32 v15, v18
  ds_write_b128 v3, v[12:15] offset:0
  ds_write_b32 v50, v45 offset:22544
  s_mov_b32 s82, 2
  s_branch qf_skip_18
qf_a1_22:
  buffer_load_dwordx4 v[12:15], v43, s[44:47], s73 offen sc1
  buffer_load_dwordx4 v[16:19], v43, s[44:47], s73 offen offset:16 sc1
qf_nx_23:
  s_sub_u32 s68, s68, 1
  s_cmp_lg_u32 s68, 0
  s_cbranch_scc1 qf_loop_19
qf_skip_18:
  s_waitcnt lgkmcnt(0)
  s_mov_b32 s68, 3200000
qflag_24:
  ds_read_b32 v36, v50 offset:22544
  s_waitcnt lgkmcnt(0)
  v_readfirstlane_b32 s33, v36
  s_cmp_lg_u32 s33, 0
  s_cbranch_scc1 qflag_ok_25
  s_sleep 1
  s_sub_u32 s68, s68, 1
  s_cmp_lg_u32 s68, 0
  s_cbranch_scc1 qflag_24
qflag_ok_25:
  v_bfe_u32 v36, v1, 2, 2
  v_lshlrev_b32 v36, 8, v36
  v_lshrrev_b32 v37, 4, v1
  v_lshl_add_u32 v36, v37, 4, v36
  ds_read_b128 v[4:7], v36 offset:0
  ds_read_b128 v[8:11], v36 offset:64
  ds_read_b128 v[12:15], v36 offset:128
  ds_read_b128 v[16:19], v36 offset:192
  s_waitcnt lgkmcnt(0)
L_loop:
  s_cmp_eq_u32 s77, 0
  s_cbranch_scc1 L_loop_done
  s_mov_b64 exec, 1
  ds_add_rtn_u32 v44, v50, v45 offset:22528
  s_mov_b64 exec, -1
  s_waitcnt vmcnt(12)
  v_mfma_f32_16x16x32_bf16 v[20:23], v[56:59], v[4:7], 0
  v_mfma_f32_16x16x32_bf16 v[20:23], v[60:63], v[8:11], v[20:23]
  v_mfma_f32_16x16x32_bf16 v[20:23], v[64:67], v[12:15], v[20:23]
  v_mfma_f32_16x16x32_bf16 v[20:23], v[68:71], v[16:19], v[20:23]
  s_waitcnt lgkmcnt(0)
  v_readfirstlane_b32 s33, v44
  s_cmp_lt_u32 s33, 84
  s_cbranch_scc1 L_fast0
  s_mov_b32 s92, 0
  s_branch L_slow
L_ret0:
  s_mov_b32 s74, s34
  s_mov_b32 s77, s35
  s_branch L_ld0
L_fast0:
  s_lshr_b32 s34, s33, 3
  s_lshl_b32 s34, s34, 17
  s_and_b32 s35, s33, 7
  s_lshl_b32 s35, s35, 12
  s_add_u32 s34, s34, s35
  s_add_u32 s34, s34, s81
  s_mov_b32 s74, s34
L_ld0:
  buffer_load_dwordx4 v[56:59], v2, s[36:39], s74 offen offset:0 nt
  buffer_load_dwordx4 v[60:63], v2, s[36:39], s74 offen offset:64 nt
  buffer_load_dwordx4 v[64:67], v2, s[36:39], s74 offen offset:128 nt
  buffer_load_dwordx4 v[68:71], v2, s[36:39], s74 offen offset:192 nt
  v_cvt_pk_bf16_f32 v36, v20, v21
  v_cvt_pk_bf16_f32 v37, v22, v23
  v_lshlrev_b32 v20, 16, v36
  v_and_b32 v21, s60, v36
  v_lshlrev_b32 v22, 16, v37
  v_and_b32 v23, s60, v37
  v_mul_f32 v20, s61, v20
  v_mul_f32 v21, s61, v21
  v_mul_f32 v22, s61, v22
  v_mul_f32 v23, s61, v23
  v_cvt_pk_bf16_f32 v36, v20, v21
  v_cvt_pk_bf16_f32 v37, v22, v23
  v_lshlrev_b32 v20, 16, v36
  v_and_b32 v21, s60, v36
  v_lshlrev_b32 v22, 16, v37
  v_and_b32 v23, s60, v37
  v_max3_f32 v36, v20, v21, v22
  v_max3_f32 v36, v36, v23, v32
  v_mov_b32 v37, v36
  s_nop 1
  v_permlane32_swap_b32 v36, v37
  s_nop 0
  v_max_f32 v36, v36, v37
  v_mov_b32 v37, v36
  s_nop 1
  v_permlane16_swap_b32 v36, v37
  s_nop 0
  v_max_f32 v36, v36, v37
  v_sub_f32 v42, v32, v36
  v_mul_f32 v43, s63, v36
  v_mul_f32 v42, s62, v42
  v_mov_b32 v32, v36
  v_exp_f32 v42, v42
  v_fma_f32 v20, v20, s62, v43
  v_fma_f32 v21, v21, s62, v43
  v_fma_f32 v22, v22, s62, v43
  v_fma_f32 v23, v23, s62, v43
  v_exp_f32 v20, v20
  v_exp_f32 v21, v21
  v_exp_f32 v22, v22
  v_exp_f32 v23, v23
  v_mul_f32 v24, v42, v24
  v_mul_f32 v25, v42, v25
  v_mul_f32 v26, v42, v26
  v_mul_f32 v27, v42, v27
  v_mul_f32 v28, v42, v28
  v_mul_f32 v29, v42, v29
  v_mul_f32 v30, v42, v30
  v_mul_f32 v31, v42, v31
  v_add_f32 v36, v20, v21
  v_add_f32 v37, v22, v23
  v_add_f32 v36, v36, v37
  v_fma_f32 v33, v33, v42, v36
  v_cvt_pk_bf16_f32 v20, v20, v20
  v_cvt_pk_bf16_f32 v21, v21, v21
  v_cvt_pk_bf16_f32 v22, v22, v22
  v_cvt_pk_bf16_f32 v23, v23, v23
  v_and_b32 v38, v34, v20
  v_and_b32 v39, v35, v20
  s_waitcnt vmcnt(12)
  v_and_b32 v40, v34, v21
  v_and_b32 v41, v35, v21
  v_mfma_f32_16x16x16_bf16 v[24:27], v[72:73], v[38:39], v[24:27]
  v_mfma_f32_16x16x16_bf16 v[28:31], v[74:75], v[38:39], v[28:31]
  v_and_b32 v38, v34, v22
  v_and_b32 v39, v35, v22
  v_mfma_f32_16x16x16_bf16 v[24:27], v[76:77], v[40:41], v[24:27]
  v_mfma_f32_16x16x16_bf16 v[28:31], v[78:79], v[40:41], v[28:31]
  v_and_b32 v40, v34, v23
  v_and_b32 v41, v35, v23
  v_mfma_f32_16x16x16_bf16 v[24:27], v[80:81], v[38:39], v[24:27]
  v_mfma_f32_16x16x16_bf16 v[28:31], v[82:83], v[38:39], v[28:31]
  v_mfma_f32_16x16x16_bf16 v[24:27], v[84:85], v[40:41], v[24:27]
  v_mfma_f32_16x16x16_bf16 v[28:31], v[86:87], v[40:41], v[28:31]
  buffer_load_dwordx4 v[72:75], v3, s[40:43], s74 offen offset:0 nt
  buffer_load_dwordx4 v[76:79], v3, s[40:43], s74 offen offset:1024 nt
  buffer_load_dwordx4 v[80:83], v3, s[40:43], s74 offen offset:2048 nt
  buffer_load_dwordx4 v[84:87], v3, s[40:43], s74 offen offset:3072 nt
  s_cmp_eq_u32 s78, 0
  s_cbranch_scc1 L_loop_done
  s_mov_b64 exec, 1
  ds_add_rtn_u32 v44, v50, v45 offset:22528
  s_mov_b64 exec, -1
  s_waitcnt vmcnt(12)
  v_mfma_f32_16x16x32_bf16 v[20:23], v[88:91], v[4:7], 0
  v_mfma_f32_16x16x32_bf16 v[20:23], v[92:95], v[8:11], v[20:23]
  v_mfma_f32_16x16x32_bf16 v[20:23], v[96:99], v[12:15], v[20:23]
  v_mfma_f32_16x16x32_bf16 v[20:23], v[100:103], v[16:19], v[20:23]
  s_waitcnt lgkmcnt(0)
  v_readfirstlane_b32 s33, v44
  s_cmp_lt_u32 s33, 84
  s_cbranch_scc1 L_fast1
  s_mov_b32 s92, 1
  s_branch L_slow
L_ret1:
  s_mov_b32 s75, s34
  s_mov_b32 s78, s35
  s_branch L_ld1
L_fast1:
  s_lshr_b32 s34, s33, 3
  s_lshl_b32 s34, s34, 17
  s_and_b32 s35, s33, 7
  s_lshl_b32 s35, s35, 12
  s_add_u32 s34, s34, s35
  s_add_u32 s34, s34, s81
  s_mov_b32 s75, s34
L_ld1:
  buffer_load_dwordx4 v[88:91], v2, s[36:39], s75 offen offset:0 nt
  buffer_load_dwordx4 v[92:95], v2, s[36:39], s75 offen offset:64 nt
  buffer_load_dwordx4 v[96:99], v2, s[36:39], s75 offen offset:128 nt
  buffer_load_dwordx4 v[100:103], v2, s[36:39], s75 offen offset:192 nt
  v_cvt_pk_bf16_f32 v36, v20, v21
  v_cvt_pk_bf16_f32 v37, v22, v23
  v_lshlrev_b32 v20, 16, v36
  v_and_b32 v21, s60, v36
  v_lshlrev_b32 v22, 16, v37
  v_and_b32 v23, s60, v37
  v_mul_f32 v20, s61, v20
  v_mul_f32 v21, s61, v21
  v_mul_f32 v22, s61, v22
  v_mul_f32 v23, s61, v23
  v_cvt_pk_bf16_f32 v36, v20, v21
  v_cvt_pk_bf16_f32 v37, v22, v23
  v_lshlrev_b32 v20, 16, v36
  v_and_b32 v21, s60, v36
  v_lshlrev_b32 v22, 16, v37
  v_and_b32 v23, s60, v37
  v_max3_f32 v36, v20, v21, v22
  v_max3_f32 v36, v36, v23, v32
  v_mov_b32 v37, v36
  s_nop 1
  v_permlane32_swap_b32 v36, v37
  s_nop 0
  v_max_f32 v36, v36, v37
  v_mov_b32 v37, v36
  s_nop 1
  v_permlane16_swap_b32 v36, v37
  s_nop 0
  v_max_f32 v36, v36, v37
  v_sub_f32 v42, v32, v36
  v_mul_f32 v43, s63, v36
  v_mul_f32 v42, s62, v42
  v_mov_b32 v32, v36
  v_exp_f32 v42, v42
  v_fma_f32 v20, v20, s62, v43
  v_fma_f32 v21, v21, s62, v43
  v_fma_f32 v22, v22, s62, v43
  v_fma_f32 v23, v23, s62, v43
  v_exp_f32 v20, v20
  v_exp_f32 v21, v21
  v_exp_f32 v22, v22
  v_exp_f32 v23, v23
  v_mul_f32 v24, v42, v24
  v_mul_f32 v25, v42, v25
  v_mul_f32 v26, v42, v26
  v_mul_f32 v27, v42, v27
  v_mul_f32 v28, v42, v28
  v_mul_f32 v29, v42, v29
  v_mul_f32 v30, v42, v30
  v_mul_f32 v31, v42, v31
  v_add_f32 v36, v20, v21
  v_add_f32 v37, v22, v23
  v_add_f32 v36, v36, v37
  v_fma_f32 v33, v33, v42, v36
  v_cvt_pk_bf16_f32 v20, v20, v20
  v_cvt_pk_bf16_f32 v21, v21, v21
  v_cvt_pk_bf16_f32 v22, v22, v22
  v_cvt_pk_bf16_f32 v23, v23, v23
  v_and_b32 v38, v34, v20
  v_and_b32 v39, v35, v20
  s_waitcnt vmcnt(12)
  v_and_b32 v40, v34, v21
  v_and_b32 v41, v35, v21
  v_mfma_f32_16x16x16_bf16 v[24:27], v[104:105], v[38:39], v[24:27]
  v_mfma_f32_16x16x16_bf16 v[28:31], v[106:107], v[38:39], v[28:31]
  v_and_b32 v38, v34, v22
  v_and_b32 v39, v35, v22
  v_mfma_f32_16x16x16_bf16 v[24:27], v[108:109], v[40:41], v[24:27]
  v_mfma_f32_16x16x16_bf16 v[28:31], v[110:111], v[40:41], v[28:31]
  v_and_b32 v40, v34, v23
  v_and_b32 v41, v35, v23
  v_mfma_f32_16x16x16_bf16 v[24:27], v[112:113], v[38:39], v[24:27]
  v_mfma_f32_16x16x16_bf16 v[28:31], v[114:115], v[38:39], v[28:31]
  v_mfma_f32_16x16x16_bf16 v[24:27], v[116:117], v[40:41], v[24:27]
  v_mfma_f32_16x16x16_bf16 v[28:31], v[118:119], v[40:41], v[28:31]
  buffer_load_dwordx4 v[104:107], v3, s[40:43], s75 offen offset:0 nt
  buffer_load_dwordx4 v[108:111], v3, s[40:43], s75 offen offset:1024 nt
  buffer_load_dwordx4 v[112:115], v3, s[40:43], s75 offen offset:2048 nt
  buffer_load_dwordx4 v[116:119], v3, s[40:43], s75 offen offset:3072 nt
  s_cmp_eq_u32 s83, 0
  s_cbranch_scc1 L_loop
bk_26:
  s_sub_u32 s83, s83, 1
  s_waitcnt vmcnt(16)
  v_mfma_f32_16x16x32_bf16 v[20:23], a[0:3], v[4:7], 0
  v_mfma_f32_16x16x32_bf16 v[20:23], a[4:7], v[8:11], v[20:23]
  v_mfma_f32_16x16x32_bf16 v[20:23], a[8:11], v[12:15], v[20:23]
  v_mfma_f32_16x16x32_bf16 v[20:23], a[12:15], v[16:19], v[20:23]
  s_nop 7
  v_cvt_pk_bf16_f32 v36, v20, v21
  v_cvt_pk_bf16_f32 v37, v22, v23
  v_lshlrev_b32 v20, 16, v36
  v_and_b32 v21, s60, v36
  v_lshlrev_b32 v22, 16, v37
  v_and_b32 v23, s60, v37
  v_mul_f32 v20, s61, v20
  v_mul_f32 v21, s61, v21
  v_mul_f32 v22, s61, v22
  v_mul_f32 v23, s61, v23
  v_cvt_pk_bf16_f32 v36, v20, v21
  v_cvt_pk_bf16_f32 v37, v22, v23
  v_lshlrev_b32 v20, 16, v36
  v_and_b32 v21, s60, v36
  v_lshlrev_b32 v22, 16, v37
  v_and_b32 v23, s60, v37
  v_max3_f32 v36, v20, v21, v22
  v_max3_f32 v36, v36, v23, v32
  v_mov_b32 v37, v36
  s_nop 1
  v_permlane32_swap_b32 v36, v37
  s_nop 0
  v_max_f32 v36, v36, v37
  v_mov_b32 v37, v36
  s_nop 1
  v_permlane16_swap_b32 v36, v37
  s_nop 0
  v_max_f32 v36, v36, v37
  v_sub_f32 v42, v32, v36
  v_mul_f32 v43, s63, v36
  v_mul_f32 v42, s62, v42
  v_mov_b32 v32, v36
  v_exp_f32 v42, v42
  v_fma_f32 v20, v20, s62, v43
  v_fma_f32 v21, v21, s62, v43
  v_fma_f32 v22, v22, s62, v43
  v_fma_f32 v23, v23, s62, v43
  v_exp_f32 v20, v20
  v_exp_f32 v21, v21
  v_exp_f32 v22, v22
  v_exp_f32 v23, v23
  v_mul_f32 v24, v42, v24
  v_mul_f32 v25, v42, v25
  v_mul_f32 v26, v42, v26
  v_mul_f32 v27, v42, v27
  v_mul_f32 v28, v42, v28
  v_mul_f32 v29, v42, v29
  v_mul_f32 v30, v42, v30
  v_mul_f32 v31, v42, v31
  v_add_f32 v36, v20, v21
  v_add_f32 v37, v22, v23
  v_add_f32 v36, v36, v37
  v_fma_f32 v33, v33, v42, v36
  v_cvt_pk_bf16_f32 v20, v20, v20
  v_cvt_pk_bf16_f32 v21, v21, v21
  v_cvt_pk_bf16_f32 v22, v22, v22
  v_cvt_pk_bf16_f32 v23, v23, v23
  v_and_b32 v38, v34, v20
  v_and_b32 v39, v35, v20
  v_and_b32 v40, v34, v21
  v_and_b32 v41, v35, v21
  v_mfma_f32_16x16x16_bf16 v[24:27], a[16:17], v[38:39], v[24:27]
  v_mfma_f32_16x16x16_bf16 v[28:31], a[18:19], v[38:39], v[28:31]
  v_and_b32 v38, v34, v22
  v_and_b32 v39, v35, v22
  v_mfma_f32_16x16x16_bf16 v[24:27], a[20:21], v[40:41], v[24:27]
  v_mfma_f32_16x16x16_bf16 v[28:31], a[22:23], v[40:41], v[28:31]
  v_and_b32 v40, v34, v23
  v_and_b32 v41, v35, v23
  v_mfma_f32_16x16x16_bf16 v[24:27], a[24:25], v[38:39], v[24:27]
  v_mfma_f32_16x16x16_bf16 v[28:31], a[26:27], v[38:39], v[28:31]
  v_mfma_f32_16x16x16_bf16 v[24:27], a[28:29], v[40:41], v[24:27]
  v_mfma_f32_16x16x16_bf16 v[28:31], a[30:31], v[40:41], v[28:31]
  v_mfma_f32_16x16x32_bf16 v[20:23], a[32:35], v[4:7], 0
  v_mfma_f32_16x16x32_bf16 v[20:23], a[36:39], v[8:11], v[20:23]
  v_mfma_f32_16x16x32_bf16 v[20:23], a[40:43], v[12:15], v[20:23]
  v_mfma_f32_16x16x32_bf16 v[20:23], a[44:47], v[16:19], v[20:23]
  s_nop 7
  v_cvt_pk_bf16_f32 v36, v20, v21
  v_cvt_pk_bf16_f32 v37, v22, v23
  v_lshlrev_b32 v20, 16, v36
  v_and_b32 v21, s60, v36
  v_lshlrev_b32 v22, 16, v37
  v_and_b32 v23, s60, v37
  v_mul_f32 v20, s61, v20
  v_mul_f32 v21, s61, v21
  v_mul_f32 v22, s61, v22
  v_mul_f32 v23, s61, v23
  v_cvt_pk_bf16_f32 v36, v20, v21
  v_cvt_pk_bf16_f32 v37, v22, v23
  v_lshlrev_b32 v20, 16, v36
  v_and_b32 v21, s60, v36
  v_lshlrev_b32 v22, 16, v37
  v_and_b32 v23, s60, v37
  v_max3_f32 v36, v20, v21, v22
  v_max3_f32 v36, v36, v23, v32
  v_mov_b32 v37, v36
  s_nop 1
  v_permlane32_swap_b32 v36, v37
  s_nop 0
  v_max_f32 v36, v36, v37
  v_mov_b32 v37, v36
  s_nop 1
  v_permlane16_swap_b32 v36, v37
  s_nop 0
  v_max_f32 v36, v36, v37
  v_sub_f32 v42, v32, v36
  v_mul_f32 v43, s63, v36
  v_mul_f32 v42, s62, v42
  v_mov_b32 v32, v36
  v_exp_f32 v42, v42
  v_fma_f32 v20, v20, s62, v43
  v_fma_f32 v21, v21, s62, v43
  v_fma_f32 v22, v22, s62, v43
  v_fma_f32 v23, v23, s62, v43
  v_exp_f32 v20, v20
  v_exp_f32 v21, v21
  v_exp_f32 v22, v22
  v_exp_f32 v23, v23
  v_mul_f32 v24, v42, v24
  v_mul_f32 v25, v42, v25
  v_mul_f32 v26, v42, v26
  v_mul_f32 v27, v42, v27
  v_mul_f32 v28, v42, v28
  v_mul_f32 v29, v42, v29
  v_mul_f32 v30, v42, v30
  v_mul_f32 v31, v42, v31
  v_add_f32 v36, v20, v21
  v_add_f32 v37, v22, v23
  v_add_f32 v36, v36, v37
  v_fma_f32 v33, v33, v42, v36
  v_cvt_pk_bf16_f32 v20, v20, v20
  v_cvt_pk_bf16_f32 v21, v21, v21
  v_cvt_pk_bf16_f32 v22, v22, v22
  v_cvt_pk_bf16_f32 v23, v23, v23
  v_and_b32 v38, v34, v20
  v_and_b32 v39, v35, v20
  v_and_b32 v40, v34, v21
  v_and_b32 v41, v35, v21
  v_mfma_f32_16x16x16_bf16 v[24:27], a[48:49], v[38:39], v[24:27]
  v_mfma_f32_16x16x16_bf16 v[28:31], a[50:51], v[38:39], v[28:31]
  v_and_b32 v38, v34, v22
  v_and_b32 v39, v35, v22
  v_mfma_f32_16x16x16_bf16 v[24:27], a[52:53], v[40:41], v[24:27]
  v_mfma_f32_16x16x16_bf16 v[28:31], a[54:55], v[40:41], v[28:31]
  v_and_b32 v40, v34, v23
  v_and_b32 v41, v35, v23
  v_mfma_f32_16x16x16_bf16 v[24:27], a[56:57], v[38:39], v[24:27]
  v_mfma_f32_16x16x16_bf16 v[28:31], a[58:59], v[38:39], v[28:31]
  v_mfma_f32_16x16x16_bf16 v[24:27], a[60:61], v[40:41], v[24:27]
  v_mfma_f32_16x16x16_bf16 v[28:31], a[62:63], v[40:41], v[28:31]
  v_mfma_f32_16x16x32_bf16 v[20:23], a[64:67], v[4:7], 0
  v_mfma_f32_16x16x32_bf16 v[20:23], a[68:71], v[8:11], v[20:23]
  v_mfma_f32_16x16x32_bf16 v[20:23], a[72:75], v[12:15], v[20:23]
  v_mfma_f32_16x16x32_bf16 v[20:23], a[76:79], v[16:19], v[20:23]
  s_nop 7
  v_cvt_pk_bf16_f32 v36, v20, v21
  v_cvt_pk_bf16_f32 v37, v22, v23
  v_lshlrev_b32 v20, 16, v36
  v_and_b32 v21, s60, v36
  v_lshlrev_b32 v22, 16, v37
  v_and_b32 v23, s60, v37
  v_mul_f32 v20, s61, v20
  v_mul_f32 v21, s61, v21
  v_mul_f32 v22, s61, v22
  v_mul_f32 v23, s61, v23
  v_cvt_pk_bf16_f32 v36, v20, v21
  v_cvt_pk_bf16_f32 v37, v22, v23
  v_lshlrev_b32 v20, 16, v36
  v_and_b32 v21, s60, v36
  v_lshlrev_b32 v22, 16, v37
  v_and_b32 v23, s60, v37
  v_max3_f32 v36, v20, v21, v22
  v_max3_f32 v36, v36, v23, v32
  v_mov_b32 v37, v36
  s_nop 1
  v_permlane32_swap_b32 v36, v37
  s_nop 0
  v_max_f32 v36, v36, v37
  v_mov_b32 v37, v36
  s_nop 1
  v_permlane16_swap_b32 v36, v37
  s_nop 0
  v_max_f32 v36, v36, v37
  v_sub_f32 v42, v32, v36
  v_mul_f32 v43, s63, v36
  v_mul_f32 v42, s62, v42
  v_mov_b32 v32, v36
  v_exp_f32 v42, v42
  v_fma_f32 v20, v20, s62, v43
  v_fma_f32 v21, v21, s62, v43
  v_fma_f32 v22, v22, s62, v43
  v_fma_f32 v23, v23, s62, v43
  v_exp_f32 v20, v20
  v_exp_f32 v21, v21
  v_exp_f32 v22, v22
  v_exp_f32 v23, v23
  v_mul_f32 v24, v42, v24
  v_mul_f32 v25, v42, v25
  v_mul_f32 v26, v42, v26
  v_mul_f32 v27, v42, v27
  v_mul_f32 v28, v42, v28
  v_mul_f32 v29, v42, v29
  v_mul_f32 v30, v42, v30
  v_mul_f32 v31, v42, v31
  v_add_f32 v36, v20, v21
  v_add_f32 v37, v22, v23
  v_add_f32 v36, v36, v37
  v_fma_f32 v33, v33, v42, v36
  v_cvt_pk_bf16_f32 v20, v20, v20
  v_cvt_pk_bf16_f32 v21, v21, v21
  v_cvt_pk_bf16_f32 v22, v22, v22
  v_cvt_pk_bf16_f32 v23, v23, v23
  v_and_b32 v38, v34, v20
  v_and_b32 v39, v35, v20
  v_and_b32 v40, v34, v21
  v_and_b32 v41, v35, v21
  v_mfma_f32_16x16x16_bf16 v[24:27], a[80:81], v[38:39], v[24:27]
  v_mfma_f32_16x16x16_bf16 v[28:31], a[82:83], v[38:39], v[28:31]
  v_and_b32 v38, v34, v22
  v_and_b32 v39, v35, v22
  v_mfma_f32_16x16x16_bf16 v[24:27], a[84:85], v[40:41], v[24:27]
  v_mfma_f32_16x16x16_bf16 v[28:31], a[86:87], v[40:41], v[28:31]
  v_and_b32 v40, v34, v23
  v_and_b32 v41, v35, v23
  v_mfma_f32_16x16x16_bf16 v[24:27], a[88:89], v[38:39], v[24:27]
  v_mfma_f32_16x16x16_bf16 v[28:31], a[90:91], v[38:39], v[28:31]
  v_mfma_f32_16x16x16_bf16 v[24:27], a[92:93], v[40:41], v[24:27]
  v_mfma_f32_16x16x16_bf16 v[28:31], a[94:95], v[40:41], v[28:31]
  v_mfma_f32_16x16x32_bf16 v[20:23], a[96:99], v[4:7], 0
  v_mfma_f32_16x16x32_bf16 v[20:23], a[100:103], v[8:11], v[20:23]
  v_mfma_f32_16x16x32_bf16 v[20:23], a[104:107], v[12:15], v[20:23]
  v_mfma_f32_16x16x32_bf16 v[20:23], a[108:111], v[16:19], v[20:23]
  s_nop 7
  v_cvt_pk_bf16_f32 v36, v20, v21
  v_cvt_pk_bf16_f32 v37, v22, v23
  v_lshlrev_b32 v20, 16, v36
  v_and_b32 v21, s60, v36
  v_lshlrev_b32 v22, 16, v37
  v_and_b32 v23, s60, v37
  v_mul_f32 v20, s61, v20
  v_mul_f32 v21, s61, v21
  v_mul_f32 v22, s61, v22
  v_mul_f32 v23, s61, v23
  v_cvt_pk_bf16_f32 v36, v20, v21
  v_cvt_pk_bf16_f32 v37, v22, v23
  v_lshlrev_b32 v20, 16, v36
  v_and_b32 v21, s60, v36
  v_lshlrev_b32 v22, 16, v37
  v_and_b32 v23, s60, v37
  v_max3_f32 v36, v20, v21, v22
  v_max3_f32 v36, v36, v23, v32
  v_mov_b32 v37, v36
  s_nop 1
  v_permlane32_swap_b32 v36, v37
  s_nop 0
  v_max_f32 v36, v36, v37
  v_mov_b32 v37, v36
  s_nop 1
  v_permlane16_swap_b32 v36, v37
  s_nop 0
  v_max_f32 v36, v36, v37
  v_sub_f32 v42, v32, v36
  v_mul_f32 v43, s63, v36
  v_mul_f32 v42, s62, v42
  v_mov_b32 v32, v36
  v_exp_f32 v42, v42
  v_fma_f32 v20, v20, s62, v43
  v_fma_f32 v21, v21, s62, v43
  v_fma_f32 v22, v22, s62, v43
  v_fma_f32 v23, v23, s62, v43
  v_exp_f32 v20, v20
  v_exp_f32 v21, v21
  v_exp_f32 v22, v22
  v_exp_f32 v23, v23
  v_mul_f32 v24, v42, v24
  v_mul_f32 v25, v42, v25
  v_mul_f32 v26, v42, v26
  v_mul_f32 v27, v42, v27
  v_mul_f32 v28, v42, v28
  v_mul_f32 v29, v42, v29
  v_mul_f32 v30, v42, v30
  v_mul_f32 v31, v42, v31
  v_add_f32 v36, v20, v21
  v_add_f32 v37, v22, v23
  v_add_f32 v36, v36, v37
  v_fma_f32 v33, v33, v42, v36
  v_cvt_pk_bf16_f32 v20, v20, v20
  v_cvt_pk_bf16_f32 v21, v21, v21
  v_cvt_pk_bf16_f32 v22, v22, v22
  v_cvt_pk_bf16_f32 v23, v23, v23
  v_and_b32 v38, v34, v20
  v_and_b32 v39, v35, v20
  v_and_b32 v40, v34, v21
  v_and_b32 v41, v35, v21
  v_mfma_f32_16x16x16_bf16 v[24:27], a[112:113], v[38:39], v[24:27]
  v_mfma_f32_16x16x16_bf16 v[28:31], a[114:115], v[38:39], v[28:31]
  v_and_b32 v38, v34, v22
  v_and_b32 v39, v35, v22
  v_mfma_f32_16x16x16_bf16 v[24:27], a[116:117], v[40:41], v[24:27]
  v_mfma_f32_16x16x16_bf16 v[28:31], a[118:119], v[40:41], v[28:31]
  v_and_b32 v40, v34, v23
  v_and_b32 v41, v35, v23
  v_mfma_f32_16x16x16_bf16 v[24:27], a[120:121], v[38:39], v[24:27]
  v_mfma_f32_16x16x16_bf16 v[28:31], a[122:123], v[38:39], v[28:31]
  v_mfma_f32_16x16x16_bf16 v[24:27], a[124:125], v[40:41], v[24:27]
  v_mfma_f32_16x16x16_bf16 v[28:31], a[126:127], v[40:41], v[28:31]
  v_mfma_f32_16x16x32_bf16 v[20:23], a[128:131], v[4:7], 0
  v_mfma_f32_16x16x32_bf16 v[20:23], a[132:135], v[8:11], v[20:23]
  v_mfma_f32_16x16x32_bf16 v[20:23], a[136:139], v[12:15], v[20:23]
  v_mfma_f32_16x16x32_bf16 v[20:23], a[140:143], v[16:19], v[20:23]
  s_nop 7
  v_cvt_pk_bf16_f32 v36, v20, v21
  v_cvt_pk_bf16_f32 v37, v22, v23
  v_lshlrev_b32 v20, 16, v36
  v_and_b32 v21, s60, v36
  v_lshlrev_b32 v22, 16, v37
  v_and_b32 v23, s60, v37
  v_mul_f32 v20, s61, v20
  v_mul_f32 v21, s61, v21
  v_mul_f32 v22, s61, v22
  v_mul_f32 v23, s61, v23
  v_cvt_pk_bf16_f32 v36, v20, v21
  v_cvt_pk_bf16_f32 v37, v22, v23
  v_lshlrev_b32 v20, 16, v36
  v_and_b32 v21, s60, v36
  v_lshlrev_b32 v22, 16, v37
  v_and_b32 v23, s60, v37
  v_max3_f32 v36, v20, v21, v22
  v_max3_f32 v36, v36, v23, v32
  v_mov_b32 v37, v36
  s_nop 1
  v_permlane32_swap_b32 v36, v37
  s_nop 0
  v_max_f32 v36, v36, v37
  v_mov_b32 v37, v36
  s_nop 1
  v_permlane16_swap_b32 v36, v37
  s_nop 0
  v_max_f32 v36, v36, v37
  v_sub_f32 v42, v32, v36
  v_mul_f32 v43, s63, v36
  v_mul_f32 v42, s62, v42
  v_mov_b32 v32, v36
  v_exp_f32 v42, v42
  v_fma_f32 v20, v20, s62, v43
  v_fma_f32 v21, v21, s62, v43
  v_fma_f32 v22, v22, s62, v43
  v_fma_f32 v23, v23, s62, v43
  v_exp_f32 v20, v20
  v_exp_f32 v21, v21
  v_exp_f32 v22, v22
  v_exp_f32 v23, v23
  v_mul_f32 v24, v42, v24
  v_mul_f32 v25, v42, v25
  v_mul_f32 v26, v42, v26
  v_mul_f32 v27, v42, v27
  v_mul_f32 v28, v42, v28
  v_mul_f32 v29, v42, v29
  v_mul_f32 v30, v42, v30
  v_mul_f32 v31, v42, v31
  v_add_f32 v36, v20, v21
  v_add_f32 v37, v22, v23
  v_add_f32 v36, v36, v37
  v_fma_f32 v33, v33, v42, v36
  v_cvt_pk_bf16_f32 v20, v20, v20
  v_cvt_pk_bf16_f32 v21, v21, v21
  v_cvt_pk_bf16_f32 v22, v22, v22
  v_cvt_pk_bf16_f32 v23, v23, v23
  v_and_b32 v38, v34, v20
  v_and_b32 v39, v35, v20
  v_and_b32 v40, v34, v21
  v_and_b32 v41, v35, v21
  v_mfma_f32_16x16x16_bf16 v[24:27], a[144:145], v[38:39], v[24:27]
  v_mfma_f32_16x16x16_bf16 v[28:31], a[146:147], v[38:39], v[28:31]
  v_and_b32 v38, v34, v22
  v_and_b32 v39, v35, v22
  v_mfma_f32_16x16x16_bf16 v[24:27], a[148:149], v[40:41], v[24:27]
  v_mfma_f32_16x16x16_bf16 v[28:31], a[150:151], v[40:41], v[28:31]
  v_and_b32 v40, v34, v23
  v_and_b32 v41, v35, v23
  v_mfma_f32_16x16x16_bf16 v[24:27], a[152:153], v[38:39], v[24:27]
  v_mfma_f32_16x16x16_bf16 v[28:31], a[154:155], v[38:39], v[28:31]
  v_mfma_f32_16x16x16_bf16 v[24:27], a[156:157], v[40:41], v[24:27]
  v_mfma_f32_16x16x16_bf16 v[28:31], a[158:159], v[40:41], v[28:31]
  v_mfma_f32_16x16x32_bf16 v[20:23], a[160:163], v[4:7], 0
  v_mfma_f32_16x16x32_bf16 v[20:23], a[164:167], v[8:11], v[20:23]
  v_mfma_f32_16x16x32_bf16 v[20:23], a[168:171], v[12:15], v[20:23]
  v_mfma_f32_16x16x32_bf16 v[20:23], a[172:175], v[16:19], v[20:23]
  s_nop 7
  v_cvt_pk_bf16_f32 v36, v20, v21
  v_cvt_pk_bf16_f32 v37, v22, v23
  v_lshlrev_b32 v20, 16, v36
  v_and_b32 v21, s60, v36
  v_lshlrev_b32 v22, 16, v37
  v_and_b32 v23, s60, v37
  v_mul_f32 v20, s61, v20
  v_mul_f32 v21, s61, v21
  v_mul_f32 v22, s61, v22
  v_mul_f32 v23, s61, v23
  v_cvt_pk_bf16_f32 v36, v20, v21
  v_cvt_pk_bf16_f32 v37, v22, v23
  v_lshlrev_b32 v20, 16, v36
  v_and_b32 v21, s60, v36
  v_lshlrev_b32 v22, 16, v37
  v_and_b32 v23, s60, v37
  v_max3_f32 v36, v20, v21, v22
  v_max3_f32 v36, v36, v23, v32
  v_mov_b32 v37, v36
  s_nop 1
  v_permlane32_swap_b32 v36, v37
  s_nop 0
  v_max_f32 v36, v36, v37
  v_mov_b32 v37, v36
  s_nop 1
  v_permlane16_swap_b32 v36, v37
  s_nop 0
  v_max_f32 v36, v36, v37
  v_sub_f32 v42, v32, v36
  v_mul_f32 v43, s63, v36
  v_mul_f32 v42, s62, v42
  v_mov_b32 v32, v36
  v_exp_f32 v42, v42
  v_fma_f32 v20, v20, s62, v43
  v_fma_f32 v21, v21, s62, v43
  v_fma_f32 v22, v22, s62, v43
  v_fma_f32 v23, v23, s62, v43
  v_exp_f32 v20, v20
  v_exp_f32 v21, v21
  v_exp_f32 v22, v22
  v_exp_f32 v23, v23
  v_mul_f32 v24, v42, v24
  v_mul_f32 v25, v42, v25
  v_mul_f32 v26, v42, v26
  v_mul_f32 v27, v42, v27
  v_mul_f32 v28, v42, v28
  v_mul_f32 v29, v42, v29
  v_mul_f32 v30, v42, v30
  v_mul_f32 v31, v42, v31
  v_add_f32 v36, v20, v21
  v_add_f32 v37, v22, v23
  v_add_f32 v36, v36, v37
  v_fma_f32 v33, v33, v42, v36
  v_cvt_pk_bf16_f32 v20, v20, v20
  v_cvt_pk_bf16_f32 v21, v21, v21
  v_cvt_pk_bf16_f32 v22, v22, v22
  v_cvt_pk_bf16_f32 v23, v23, v23
  v_and_b32 v38, v34, v20
  v_and_b32 v39, v35, v20
  v_and_b32 v40, v34, v21
  v_and_b32 v41, v35, v21
  v_mfma_f32_16x16x16_bf16 v[24:27], a[176:177], v[38:39], v[24:27]
  v_mfma_f32_16x16x16_bf16 v[28:31], a[178:179], v[38:39], v[28:31]
  v_and_b32 v38, v34, v22
  v_and_b32 v39, v35, v22
  v_mfma_f32_16x16x16_bf16 v[24:27], a[180:181], v[40:41], v[24:27]
  v_mfma_f32_16x16x16_bf16 v[28:31], a[182:183], v[40:41], v[28:31]
  v_and_b32 v40, v34, v23
  v_and_b32 v41, v35, v23
  v_mfma_f32_16x16x16_bf16 v[24:27], a[184:185], v[38:39], v[24:27]
  v_mfma_f32_16x16x16_bf16 v[28:31], a[186:187], v[38:39], v[28:31]
  v_mfma_f32_16x16x16_bf16 v[24:27], a[188:189], v[40:41], v[24:27]
  v_mfma_f32_16x16x16_bf16 v[28:31], a[190:191], v[40:41], v[28:31]
  s_branch L_loop
L_slow:
  s_cmp_lg_u32 s33, 84
  s_cbranch_scc1 L_sl1
  s_memrealtime s[90:91]
  s_lshl_b32 s35, s31, 8
  s_lshl_b32 s93, s32, 3
  s_add_u32 s35, s35, s93
  s_add_u32 s35, s35, 4096
  s_waitcnt lgkmcnt(0)
  s_sub_u32 s34, s90, s89
  s_min_u32 s34, s34, 4095
  s_lshl_b32 s34, s34, 20
  s_and_b32 s90, s90, 0xfffff
  s_or_b32 s34, s34, s90
  v_mov_b32 v38, s34
  v_mov_b32 v39, s30
  s_mov_b64 exec, 1
  buffer_store_dwordx2 v[38:39], v50, s[44:47], s35 offen sc1
  s_mov_b64 exec, -1
L_sl1:
  s_cmp_lg_u32 s33, 95
  s_cbranch_scc1 L_sl2
  v_and_b32 v36, 31, v1
  v_lshlrev_b32 v36, 3, v36
  s_lshl_b32 s35, s31, 8
  s_add_u32 s35, s35, 4096
  buffer_load_dwordx2 v[46:47], v36, s[44:47], s35 offen sc1
  s_mov_b32 s88, 2
  s_branch L_sl3
L_sl2:
  s_cmp_eq_u32 s88, 0
  s_cbranch_scc1 L_sl3
  s_sub_u32 s88, s88, 1
  s_cmp_lg_u32 s88, 0
  s_cbranch_scc1 L_sl3
  s_mov_b32 s93, 0
L_alloc:
  v_cmp_ne_u32 vcc, s30, v47
  s_nop 0
  s_cbranch_vccz L_alloc_ok
  v_and_b32 v36, 31, v1
  v_lshlrev_b32 v36, 3, v36
  s_lshl_b32 s35, s31, 8
  s_add_u32 s35, s35, 4096
  buffer_load_dwordx2 v[46:47], v36, s[44:47], s35 offen sc1
  s_mov_b32 s88, 2
  s_cmp_eq_u32 s93, 0
  s_cbranch_scc1 L_sl3
  s_mov_b32 s88, 0
  s_waitcnt vmcnt(0)
  s_add_u32 s93, s93, 1
  s_cmp_lt_u32 s93, 200000
  s_cbranch_scc1 L_alloc
L_alloc_ok:
  v_readfirstlane_b32 s34, v46
  v_lshrrev_b32 v37, 20, v46
  v_cvt_f32_u32 v37, v37
  s_nop 0
  v_subrev_u32 v36, s34, v46
  v_bfe_i32 v36, v36, 0, 20
  v_cvt_f32_i32 v36, v36
  v_mov_b32 v38, v36
  s_nop 1
  v_add_f32_dpp v37, v37, v37 quad_perm:[1,0,3,2] row_mask:0xf bank_mask:0xf
  v_add_f32_dpp v38, v38, v38 quad_perm:[1,0,3,2] row_mask:0xf bank_mask:0xf
  s_nop 1
  v_add_f32_dpp v37, v37, v37 quad_perm:[2,3,0,1] row_mask:0xf bank_mask:0xf
  v_add_f32_dpp v38, v38, v38 quad_perm:[2,3,0,1] row_mask:0xf bank_mask:0xf
  s_nop 1
  v_add_f32_dpp v37, v37, v37 row_half_mirror row_mask:0xf bank_mask:0xf
  v_add_f32_dpp v38, v38, v38 row_half_mirror row_mask:0xf bank_mask:0xf
  s_nop 1
  v_add_f32_dpp v37, v37, v37 row_mirror row_mask:0xf bank_mask:0xf
  v_add_f32_dpp v38, v38, v38 row_mirror row_mask:0xf bank_mask:0xf
  v_mov_b32 v39, v37
  s_nop 1
  v_permlane16_swap_b32 v37, v39
  s_nop 0
  v_add_f32 v37, v37, v39
  v_mov_b32 v39, v38
  s_nop 1
  v_permlane16_swap_b32 v38, v39
  s_nop 0
  v_add_f32 v38, v38, v39
  v_rcp_f32 v37, v37
  v_mul_f32 v38, 0x3d000000, v38
  v_sub_f32 v36, v36, v38
  v_mul_f32 v37, 0xc5280000, v37
  v_mov_b32 v38, 0x41c00000
  v_fmac_f32 v38, v36, v37
  v_and_b32 v39, 3, v1
  v_and_b32 v40, 31, v1
  v_cmp_eq_u32 vcc, 1, v39
  v_cmp_gt_u32 s[90:91], 28, v40
  v_mov_b32 v39, 0x40a00000
  s_and_b64 vcc, vcc, s[90:91]
  s_nop 0
  v_cndmask_b32 v39, 0, v39, vcc
  v_sub_f32 v38, v38, v39
  v_max_f32 v38, 0, v38
  s_nop 1
  v_add_f32_dpp v38, v38, v38 row_shr:1 row_mask:0xf bank_mask:0xf bound_ctrl:0
  s_nop 1
  v_add_f32_dpp v38, v38, v38 row_shr:2 row_mask:0xf bank_mask:0xf bound_ctrl:0
  s_nop 1
  v_add_f32_dpp v38, v38, v38 row_shr:4 row_mask:0xf bank_mask:0xf bound_ctrl:0
  s_nop 1
  v_add_f32_dpp v38, v38, v38 row_shr:8 row_mask:0xf bank_mask:0xf bound_ctrl:0
  s_nop 1
  v_add_f32_dpp v38, v38, v38 row_bcast:15 row_mask:0xa bank_mask:0xf
  s_nop 0
  v_readlane_b32 s34, v38, 31
  s_nop 1
  v_rcp_f32 v39, s34
  s_max_u32 s35, s32, 1
  s_sub_u32 s35, s35, 1
  v_mul_f32 v39, 0x44400000, v39
  v_mul_f32 v38, v38, v39
  v_rndne_f32 v38, v38
  v_cvt_u32_f32 v38, v38
  v_min_u32 v38, 768, v38
  s_nop 0
  v_readlane_b32 s86, v38, s32
  v_readlane_b32 s85, v38, s35
  s_cmp_eq_u32 s32, 31
  s_cselect_b32 s86, 768, s86
  s_cmp_eq_u32 s32, 0
  s_cselect_b32 s85, 0, s85
  s_sub_u32 s86, s86, s85
  s_lshl_b32 s85, s85, 12
  s_add_u32 s85, s85, 13631488
  v_mov_b32 v38, s85
  v_mov_b32 v39, s86
  ds_write_b64 v50, v[38:39] offset:22536
  s_mov_b32 s87, 1
L_sl3:
  s_cmp_ge_u32 s33, 104
  s_cbranch_scc1 L_ext
  s_lshr_b32 s34, s33, 3
  s_lshl_b32 s34, s34, 17
  s_and_b32 s35, s33, 7
  s_lshl_b32 s35, s35, 12
  s_add_u32 s34, s34, s35
  s_add_u32 s34, s34, s81
  s_mov_b32 s35, 1
  s_branch L_slret
L_ext:
  s_cmp_lg_u32 s87, 0
  s_cbranch_scc1 L_ext_ok
  s_cmp_eq_u32 s88, 0
  s_cbranch_scc1 L_ext_wait
  s_mov_b32 s88, 0
  s_mov_b32 s93, 1
  s_waitcnt vmcnt(0)
  s_branch L_alloc
L_ext_wait:
  s_mov_b32 s93, 1600000
L_ext_spin:
  ds_read_b64 v[38:39], v50 offset:22536
  s_waitcnt lgkmcnt(0)
  v_readfirstlane_b32 s85, v38
  v_readfirstlane_b32 s86, v39
  s_cmp_lg_u32 s86, -1
  s_cbranch_scc1 L_ext_got
  s_sleep 1
  s_sub_u32 s93, s93, 1
  s_cmp_lg_u32 s93, 0
  s_cbranch_scc1 L_ext_spin
  s_mov_b32 s86, 0
L_ext_got:
  s_mov_b32 s87, 1
L_ext_ok:
  s_sub_u32 s35, s33, 104
  s_lshl_b32 s34, s35, 12
  s_add_u32 s34, s34, s85
  s_cmp_lt_u32 s35, s86
  s_cselect_b32 s34, s34, 0x40000000
  s_cselect_b32 s35, 1, 0
L_slret:
  s_cmp_eq_u32 s92, 0
  s_cbranch_scc1 L_ret0
  s_branch L_ret1
L_loop_done:
  s_nop 3
  s_lshl_b32 s33, s28, 11
  v_lshl_add_u32 v36, v1, 4, s33
  ds_write_b128 v36, v[24:27] offset:1024
  ds_write_b128 v36, v[28:31] offset:2048
  s_lshl_b32 s33, s28, 8
  v_lshl_add_u32 v36, v1, 2, s33
  ds_write_b32 v36, v32 offset:9216
  ds_write_b32 v36, v33 offset:10240
  s_waitcnt lgkmcnt(0)
  s_barrier
  s_cmp_ge_u32 s28, 2
  s_cbranch_scc1 L_after_publish
  v_lshlrev_b32 v36, 2, v1
  ds_read_b32 v4, v36 offset:9216
  ds_read_b32 v8, v36 offset:10240
  ds_read_b32 v5, v36 offset:9472
  ds_read_b32 v9, v36 offset:10496
  ds_read_b32 v6, v36 offset:9728
  ds_read_b32 v10, v36 offset:10752
  ds_read_b32 v7, v36 offset:9984
  ds_read_b32 v11, v36 offset:11008
  s_lshl_b32 s33, s28, 10
  v_lshl_add_u32 v36, v1, 4, s33
  ds_read_b128 v[12:15], v36 offset:1024
  ds_read_b128 v[16:19], v36 offset:3072
  ds_read_b128 v[20:23], v36 offset:5120
  ds_read_b128 v[24:27], v36 offset:7168
  s_lshl_b32 s33, s31, 5
  s_add_u32 s33, s33, s32
  s_lshl_b32 s34, s33, 11
  s_lshl_b32 s35, s28, 8
  s_add_u32 s34, s34, s35
  s_add_u32 s34, s34, 131072
  s_waitcnt lgkmcnt(4)
  v_max3_f32 v32, v4, v5, v6
  v_max_f32 v32, v32, v7
  v_sub_f32 v4, v4, v32
  v_sub_f32 v5, v5, v32
  v_sub_f32 v6, v6, v32
  v_sub_f32 v7, v7, v32
  v_mul_f32 v4, s62, v4
  v_mul_f32 v5, s62, v5
  v_mul_f32 v6, s62, v6
  v_mul_f32 v7, s62, v7
  v_exp_f32 v4, v4
  v_exp_f32 v5, v5
  v_exp_f32 v6, v6
  v_exp_f32 v7, v7
  s_waitcnt lgkmcnt(0)
  v_mul_f32 v28, v4, v12
  v_mul_f32 v29, v4, v13
  v_mul_f32 v30, v4, v14
  v_mul_f32 v31, v4, v15
  v_fmac_f32 v28, v5, v16
  v_fmac_f32 v29, v5, v17
  v_fmac_f32 v30, v5, v18
  v_fmac_f32 v31, v5, v19
  v_fmac_f32 v28, v6, v20
  v_fmac_f32 v29, v6, v21
  v_fmac_f32 v30, v6, v22
  v_fmac_f32 v31, v6, v23
  v_fmac_f32 v28, v7, v24
  v_fmac_f32 v29, v7, v25
  v_fmac_f32 v30, v7, v26
  v_fmac_f32 v31, v7, v27
  v_bfi_b32 v28, s49, v54, v28
  v_bfi_b32 v29, s49, v54, v29
  v_bfi_b32 v30, s49, v54, v30
  v_bfi_b32 v31, s49, v54, v31
  buffer_store_dwordx4 v[28:31], v55, s[44:47], s34 offen sc1
  s_cmp_lg_u32 s28, 0
  s_cbranch_scc1 L_after_publish
  v_mul_f32 v33, v4, v8
  v_fmac_f32 v33, v5, v9
  v_fmac_f32 v33, v6, v10
  v_fmac_f32 v33, v7, v11
  v_mov_b32 v37, v33
  s_nop 1
  v_permlane32_swap_b32 v33, v37
  s_nop 0
  v_add_f32 v33, v33, v37
  v_mov_b32 v37, v33
  s_nop 1
  v_permlane16_swap_b32 v33, v37
  s_nop 0
  v_add_f32 v33, v33, v37
  s_lshl_b32 s34, s33, 6
  s_add_u32 s34, s34, 8192
  v_lshlrev_b32 v36, 2, v1
  v_mov_b32 v34, s30
  v_mov_b32 v35, s30
  s_mov_b64 exec, 0x1111
  buffer_store_dwordx4 v[32:35], v36, s[44:47], s34 offen sc1
  s_mov_b64 exec, -1
L_after_publish:
  s_cmp_eq_u32 s70, 0
  s_cbranch_scc1 L_end
  s_cmp_eq_u32 s70, 1
  s_cbranch_scc1 L_roleB
  s_cmp_lg_u32 s70, 1
  s_cbranch_scc1 pf_notB_28
  s_lshl_b32 s33, s31, 2
  s_and_b32 s34, s32, 2
  s_add_u32 s33, s33, s34
  s_lshr_b32 s34, s28, 1
  s_add_u32 s33, s33, s34
  s_lshl_b32 s33, s33, 17
  s_and_b32 s34, s28, 1
  s_lshl_b32 s34, s34, 12
  s_add_u32 s33, s33, s34
  s_lshr_b32 s34, s32, 2
  s_lshl_b32 s34, s34, 7
  s_add_u32 s33, s33, s34
  s_add_u32 s52, s12, s33
  s_addc_u32 s53, s13, 0
  s_mov_b32 s54, 126080
  s_mov_b32 s55, 0x00020000
  v_lshrrev_b32 v36, 4, v1
  v_lshlrev_b32 v36, 15, v36
  v_bfe_u32 v37, v1, 3, 1
  v_lshl_add_u32 v36, v37, 11, v36
  v_and_b32 v37, 7, v1
  v_lshl_add_u32 v36, v37, 4, v36
  s_mov_b32 s34, 0
  buffer_load_dwordx4 a[0:3], v36, s[52:55], s34 offen offset:0 nt
  s_mov_b32 s34, 8192
  buffer_load_dwordx4 a[4:7], v36, s[52:55], s34 offen offset:0 nt
  s_mov_b32 s34, 16384
  buffer_load_dwordx4 a[8:11], v36, s[52:55], s34 offen offset:0 nt
  s_mov_b32 s34, 24576
  buffer_load_dwordx4 a[12:15], v36, s[52:55], s34 offen offset:0 nt
  s_mov_b32 s34, 0
  buffer_load_dwordx4 a[16:19], v36, s[52:55], s34 offen offset:1024 nt
  s_mov_b32 s34, 8192
  buffer_load_dwordx4 a[20:23], v36, s[52:55], s34 offen offset:1024 nt
  s_mov_b32 s34, 16384
  buffer_load_dwordx4 a[24:27], v36, s[52:55], s34 offen offset:1024 nt
  s_mov_b32 s34, 24576
  buffer_load_dwordx4 a[28:31], v36, s[52:55], s34 offen offset:1024 nt
  s_branch pf_done_27
pf_notB_28:
  s_cmp_lg_u32 s70, 2
  s_cbranch_scc1 pf_done_27
  s_lshl_b32 s34, s3, 6
  s_mul_i32 s35, s28, 458752
  s_add_u32 s34, s34, s35
  s_add_u32 s52, s16, s34
  s_addc_u32 s53, s17, 0
  s_mov_b32 s54, 455232
  s_mov_b32 s55, 0x00020000
  s_add_u32 s56, s18, s34
  s_addc_u32 s57, s19, 0
  s_mov_b32 s58, 455232
  s_mov_b32 s59, 0x00020000
  v_lshrrev_b32 v36, 2, v1
  v_mul_u32_u24 v36, 28672, v36
  v_and_b32 v37, 3, v1
  v_lshl_add_u32 v36, v37, 4, v36
  s_mov_b32 s35, 0
  buffer_load_dwordx4 a[0:3], v36, s[52:55], s35 offen nt
  buffer_load_dwordx4 a[32:35], v36, s[56:59], s35 offen nt
  s_mov_b32 s35, 3584
  buffer_load_dwordx4 a[4:7], v36, s[52:55], s35 offen nt
  buffer_load_dwordx4 a[36:39], v36, s[56:59], s35 offen nt
  s_mov_b32 s35, 7168
  buffer_load_dwordx4 a[8:11], v36, s[52:55], s35 offen nt
  buffer_load_dwordx4 a[40:43], v36, s[56:59], s35 offen nt
  s_mov_b32 s35, 10752
  buffer_load_dwordx4 a[12:15], v36, s[52:55], s35 offen nt
  buffer_load_dwordx4 a[44:47], v36, s[56:59], s35 offen nt
  s_mov_b32 s35, 14336
  buffer_load_dwordx4 a[16:19], v36, s[52:55], s35 offen nt
  buffer_load_dwordx4 a[48:51], v36, s[56:59], s35 offen nt
  s_mov_b32 s35, 17920
  buffer_load_dwordx4 a[20:23], v36, s[52:55], s35 offen nt
  buffer_load_dwordx4 a[52:55], v36, s[56:59], s35 offen nt
  s_mov_b32 s35, 21504
  buffer_load_dwordx4 a[24:27], v36, s[52:55], s35 offen nt
  buffer_load_dwordx4 a[56:59], v36, s[56:59], s35 offen nt
  s_mov_b32 s35, 25088
  buffer_load_dwordx4 a[28:31], v36, s[52:55], s35 offen nt
  buffer_load_dwordx4 a[60:63], v36, s[56:59], s35 offen nt
  s_lshl_b32 s34, s3, 15
  s_lshl_b32 s35, s28, 8
  s_add_u32 s34, s34, s35
  s_add_u32 s52, s20, s34
  s_addc_u32 s53, s21, 0
  s_mov_b32 s54, 32000
  s_mov_b32 s55, 0x00020000
  v_lshrrev_b32 v36, 4, v1
  v_lshlrev_b32 v36, 13, v36
  v_and_b32 v37, 15, v1
  v_lshl_add_u32 v36, v37, 4, v36
  s_mov_b32 s35, 0
  buffer_load_dwordx4 a[64:67], v36, s[52:55], s35 offen offset:0 nt
  s_mov_b32 s35, 0
  buffer_load_dwordx4 a[68:71], v36, s[52:55], s35 offen offset:1024 nt
  s_mov_b32 s35, 0
  buffer_load_dwordx4 a[72:75], v36, s[52:55], s35 offen offset:2048 nt
  s_mov_b32 s35, 0
  buffer_load_dwordx4 a[76:79], v36, s[52:55], s35 offen offset:3072 nt
  s_mov_b32 s35, 4096
  buffer_load_dwordx4 a[80:83], v36, s[52:55], s35 offen offset:0 nt
  s_mov_b32 s35, 4096
  buffer_load_dwordx4 a[84:87], v36, s[52:55], s35 offen offset:1024 nt
  s_mov_b32 s35, 4096
  buffer_load_dwordx4 a[88:91], v36, s[52:55], s35 offen offset:2048 nt
  s_mov_b32 s35, 4096
  buffer_load_dwordx4 a[92:95], v36, s[52:55], s35 offen offset:3072 nt
pf_done_27:
  s_cmp_eq_u32 s70, 2
  s_cbranch_scc1 L_roleC
  s_branch L_roleE
L_roleB:
  s_and_b32 s33, s32, 2
  s_lshr_b32 s34, s28, 1
  s_add_u32 s33, s33, s34
  s_lshl_b32 s34, s31, 16
  s_lshl_b32 s35, s33, 9
  s_add_u32 s34, s34, s35
  s_and_b32 s35, s28, 1
  s_lshl_b32 s35, s35, 8
  s_add_u32 s34, s34, s35
  s_add_u32 s34, s34, 131072
  v_lshrrev_b32 v8, 4, v1
  v_lshlrev_b32 v10, 11, v8
  v_and_b32 v9, 15, v1
  v_lshl_add_u32 v2, v9, 4, v10
  v_add_u32 v2, s34, v2
  s_lshl_b32 s34, s31, 11
  s_lshl_b32 s35, s33, 4
  s_add_u32 s34, s34, s35
  s_add_u32 s34, s34, 8192
  v_and_b32 v9, 7, v1
  v_lshlrev_b32 v9, 8, v9
  v_lshl_add_u32 v3, v8, 6, v9
  v_add_u32 v3, s34, v3
  s_cmp_lg_u32 s70, 1
  s_cbranch_scc1 pf_notB_33
  s_lshl_b32 s33, s31, 2
  s_and_b32 s34, s32, 2
  s_add_u32 s33, s33, s34
  s_lshr_b32 s34, s28, 1
  s_add_u32 s33, s33, s34
  s_lshl_b32 s33, s33, 17
  s_and_b32 s34, s28, 1
  s_lshl_b32 s34, s34, 12
  s_add_u32 s33, s33, s34
  s_lshr_b32 s34, s32, 2
  s_lshl_b32 s34, s34, 7
  s_add_u32 s33, s33, s34
  s_add_u32 s52, s12, s33
  s_addc_u32 s53, s13, 0
  s_mov_b32 s54, 126080
  s_mov_b32 s55, 0x00020000
  v_lshrrev_b32 v36, 4, v1
  v_lshlrev_b32 v36, 15, v36
  v_bfe_u32 v37, v1, 3, 1
  v_lshl_add_u32 v36, v37, 11, v36
  v_and_b32 v37, 7, v1
  v_lshl_add_u32 v36, v37, 4, v36
  s_mov_b32 s34, 0
  buffer_load_dwordx4 a[0:3], v36, s[52:55], s34 offen offset:0 nt
  s_mov_b32 s34, 8192
  buffer_load_dwordx4 a[4:7], v36, s[52:55], s34 offen offset:0 nt
  s_mov_b32 s34, 16384
  buffer_load_dwordx4 a[8:11], v36, s[52:55], s34 offen offset:0 nt
  s_mov_b32 s34, 24576
  buffer_load_dwordx4 a[12:15], v36, s[52:55], s34 offen offset:0 nt
  s_mov_b32 s34, 0
  buffer_load_dwordx4 a[16:19], v36, s[52:55], s34 offen offset:1024 nt
  s_mov_b32 s34, 8192
  buffer_load_dwordx4 a[20:23], v36, s[52:55], s34 offen offset:1024 nt
  s_mov_b32 s34, 16384
  buffer_load_dwordx4 a[24:27], v36, s[52:55], s34 offen offset:1024 nt
  s_mov_b32 s34, 24576
  buffer_load_dwordx4 a[28:31], v36, s[52:55], s34 offen offset:1024 nt
  s_branch pf_done_32
pf_notB_33:
  s_cmp_lg_u32 s70, 2
  s_cbranch_scc1 pf_done_32
  s_lshl_b32 s34, s3, 6
  s_mul_i32 s35, s28, 458752
  s_add_u32 s34, s34, s35
  s_add_u32 s52, s16, s34
  s_addc_u32 s53, s17, 0
  s_mov_b32 s54, 455232
  s_mov_b32 s55, 0x00020000
  s_add_u32 s56, s18, s34
  s_addc_u32 s57, s19, 0
  s_mov_b32 s58, 455232
  s_mov_b32 s59, 0x00020000
  v_lshrrev_b32 v36, 2, v1
  v_mul_u32_u24 v36, 28672, v36
  v_and_b32 v37, 3, v1
  v_lshl_add_u32 v36, v37, 4, v36
  s_mov_b32 s35, 0
  buffer_load_dwordx4 a[0:3], v36, s[52:55], s35 offen nt
  buffer_load_dwordx4 a[32:35], v36, s[56:59], s35 offen nt
  s_mov_b32 s35, 3584
  buffer_load_dwordx4 a[4:7], v36, s[52:55], s35 offen nt
  buffer_load_dwordx4 a[36:39], v36, s[56:59], s35 offen nt
  s_mov_b32 s35, 7168
  buffer_load_dwordx4 a[8:11], v36, s[52:55], s35 offen nt
  buffer_load_dwordx4 a[40:43], v36, s[56:59], s35 offen nt
  s_mov_b32 s35, 10752
  buffer_load_dwordx4 a[12:15], v36, s[52:55], s35 offen nt
  buffer_load_dwordx4 a[44:47], v36, s[56:59], s35 offen nt
  s_mov_b32 s35, 14336
  buffer_load_dwordx4 a[16:19], v36, s[52:55], s35 offen nt
  buffer_load_dwordx4 a[48:51], v36, s[56:59], s35 offen nt
  s_mov_b32 s35, 17920
  buffer_load_dwordx4 a[20:23], v36, s[52:55], s35 offen nt
  buffer_load_dwordx4 a[52:55], v36, s[56:59], s35 offen nt
  s_mov_b32 s35, 21504
  buffer_load_dwordx4 a[24:27], v36, s[52:55], s35 offen nt
  buffer_load_dwordx4 a[56:59], v36, s[56:59], s35 offen nt
  s_mov_b32 s35, 25088
  buffer_load_dwordx4 a[28:31], v36, s[52:55], s35 offen nt
  buffer_load_dwordx4 a[60:63], v36, s[56:59], s35 offen nt
  s_lshl_b32 s34, s3, 15
  s_lshl_b32 s35, s28, 8
  s_add_u32 s34, s34, s35
  s_add_u32 s52, s20, s34
  s_addc_u32 s53, s21, 0
  s_mov_b32 s54, 32000
  s_mov_b32 s55, 0x00020000
  v_lshrrev_b32 v36, 4, v1
  v_lshlrev_b32 v36, 13, v36
  v_and_b32 v37, 15, v1
  v_lshl_add_u32 v36, v37, 4, v36
  s_mov_b32 s35, 0
  buffer_load_dwordx4 a[64:67], v36, s[52:55], s35 offen offset:0 nt
  s_mov_b32 s35, 0
  buffer_load_dwordx4 a[68:71], v36, s[52:55], s35 offen offset:1024 nt
  s_mov_b32 s35, 0
  buffer_load_dwordx4 a[72:75], v36, s[52:55], s35 offen offset:2048 nt
  s_mov_b32 s35, 0
  buffer_load_dwordx4 a[76:79], v36, s[52:55], s35 offen offset:3072 nt
  s_mov_b32 s35, 4096
  buffer_load_dwordx4 a[80:83], v36, s[52:55], s35 offen offset:0 nt
  s_mov_b32 s35, 4096
  buffer_load_dwordx4 a[84:87], v36, s[52:55], s35 offen offset:1024 nt
  s_mov_b32 s35, 4096
  buffer_load_dwordx4 a[88:91], v36, s[52:55], s35 offen offset:2048 nt
  s_mov_b32 s35, 4096
  buffer_load_dwordx4 a[92:95], v36, s[52:55], s35 offen offset:3072 nt
pf_done_32:
  s_mov_b64 s[76:77], -1
  s_mov_b64 s[78:79], -1
  s_mov_b64 s[80:81], -1
  s_mov_b64 s[82:83], -1
  s_mov_b64 s[84:85], -1
  s_mov_b64 s[86:87], -1
  s_mov_b64 s[88:89], -1
  s_mov_b64 s[90:91], -1
  s_mov_b64 s[66:67], -1
  s_mov_b32 s68, 200000
  s_mov_b32 s93, 1
B_round_29:
  s_mov_b64 exec, s[66:67]
  s_cbranch_execz B_noml_34
  buffer_load_dwordx4 v[4:7], v3, s[44:47], 0 offen sc1
B_noml_34:
  s_mov_b64 exec, s[76:77]
  s_cbranch_execz B_sk_35
  s_mov_b32 s35, 0
  buffer_load_dwordx4 v[56:59], v2, s[44:47], s35 offen sc1
B_sk_35:
  s_mov_b64 exec, s[78:79]
  s_cbranch_execz B_sk_36
  s_mov_b32 s35, 8192
  buffer_load_dwordx4 v[60:63], v2, s[44:47], s35 offen sc1
B_sk_36:
  s_mov_b64 exec, s[80:81]
  s_cbranch_execz B_sk_37
  s_mov_b32 s35, 16384
  buffer_load_dwordx4 v[64:67], v2, s[44:47], s35 offen sc1
B_sk_37:
  s_mov_b64 exec, s[82:83]
  s_cbranch_execz B_sk_38
  s_mov_b32 s35, 24576
  buffer_load_dwordx4 v[68:71], v2, s[44:47], s35 offen sc1
B_sk_38:
  s_mov_b64 exec, s[84:85]
  s_cbranch_execz B_sk_39
  s_mov_b32 s35, 32768
  buffer_load_dwordx4 v[72:75], v2, s[44:47], s35 offen sc1
B_sk_39:
  s_mov_b64 exec, s[86:87]
  s_cbranch_execz B_sk_40
  s_mov_b32 s35, 40960
  buffer_load_dwordx4 v[76:79], v2, s[44:47], s35 offen sc1
B_sk_40:
  s_mov_b64 exec, s[88:89]
  s_cbranch_execz B_sk_41
  s_mov_b32 s35, 49152
  buffer_load_dwordx4 v[80:83], v2, s[44:47], s35 offen sc1
B_sk_41:
  s_mov_b64 exec, s[90:91]
  s_cbranch_execz B_sk_42
  s_mov_b32 s35, 57344
  buffer_load_dwordx4 v[84:87], v2, s[44:47], s35 offen sc1
B_sk_42:
  s_mov_b64 exec, -1
  s_cmp_eq_u32 s93, 0
  s_cbranch_scc1 B_first_31
  s_mov_b32 s93, 0
  v_and_b32 v8, 1, v1
  v_mov_b32 v9, 0xffff
  v_mov_b32 v10, s60
  v_cmp_eq_u32 vcc, 1, v8
  s_nop 1
  v_cndmask_b32 v9, v9, v10, vcc
  v_bfe_u32 v8, v1, 1, 2
  v_cmp_eq_u32 vcc, 0, v8
  s_nop 1
  v_cndmask_b32 v12, 0, v9, vcc
  v_cmp_eq_u32 vcc, 1, v8
  s_nop 1
  v_cndmask_b32 v13, 0, v9, vcc
  v_cmp_eq_u32 vcc, 2, v8
  s_nop 1
  v_cndmask_b32 v14, 0, v9, vcc
  v_cmp_eq_u32 vcc, 3, v8
  s_nop 1
  v_cndmask_b32 v15, 0, v9, vcc
  s_lshl_b32 s34, s28, 8
  v_and_b32 v8, 15, v1
  v_lshlrev_b32 v8, 4, v8
  v_lshrrev_b32 v9, 4, v1
  v_lshl_add_u32 v8, v9, 2, v8
  v_add_u32 v40, s34, v8
  v_lshrrev_b32 v8, 3, v1
  v_lshlrev_b32 v8, 5, v8
  v_add_u32 v41, s34, v8
  s_lshl_b32 s34, s28, 9
  v_lshrrev_b32 v8, 5, v1
  v_lshlrev_b32 v8, 8, v8
  v_bfe_u32 v9, v1, 4, 1
  v_lshl_add_u32 v8, v9, 7, v8
  v_and_b32 v9, 7, v1
  v_lshl_add_u32 v8, v9, 2, v8
  v_add_u32 v42, s34, v8
  s_lshl_b32 s94, s31, 1
  s_bfe_u32 s35, s32, 0x10001
  s_add_u32 s94, s94, s35
  s_lshl_b32 s94, s94, 11
  s_lshr_b32 s35, s32, 2
  s_lshl_b32 s35, s35, 8
  s_add_u32 s94, s94, s35
  s_add_u32 s94, s94, 32768
  s_waitcnt vmcnt(0)
  s_branch B_w1_43
B_first_31:
  s_waitcnt vmcnt(0)
B_w1_43:
  v_xor_b32 v8, s30, v6
  v_bitop3_b32 v8, v8, v7, s30 bitop3:0xf6
  v_cmp_ne_u32 s[66:67], 0, v8
  s_mov_b64 s[96:97], 0
  s_mov_b64 exec, s[76:77]
  s_cbranch_execz B_ck_44
  v_xor_b32 v8, s71, v56
  v_bitop3_b32 v8, v8, v57, s71 bitop3:0xf6
  v_bitop3_b32 v8, v8, v58, s71 bitop3:0xf6
  v_bitop3_b32 v8, v8, v59, s71 bitop3:0xf6
  v_and_b32 v8, s49, v8
  v_cmp_ne_u32 s[76:77], 0, v8
  s_or_b64 s[96:97], s[96:97], s[76:77]
B_ck_44:
  s_mov_b64 exec, s[78:79]
  s_cbranch_execz B_ck_45
  v_xor_b32 v8, s71, v60
  v_bitop3_b32 v8, v8, v61, s71 bitop3:0xf6
  v_bitop3_b32 v8, v8, v62, s71 bitop3:0xf6
  v_bitop3_b32 v8, v8, v63, s71 bitop3:0xf6
  v_and_b32 v8, s49, v8
  v_cmp_ne_u32 s[78:79], 0, v8
  s_or_b64 s[96:97], s[96:97], s[78:79]
B_ck_45:
  s_mov_b64 exec, s[80:81]
  s_cbranch_execz B_ck_46
  v_xor_b32 v8, s71, v64
  v_bitop3_b32 v8, v8, v65, s71 bitop3:0xf6
  v_bitop3_b32 v8, v8, v66, s71 bitop3:0xf6
  v_bitop3_b32 v8, v8, v67, s71 bitop3:0xf6
  v_and_b32 v8, s49, v8
  v_cmp_ne_u32 s[80:81], 0, v8
  s_or_b64 s[96:97], s[96:97], s[80:81]
B_ck_46:
  s_mov_b64 exec, s[82:83]
  s_cbranch_execz B_ck_47
  v_xor_b32 v8, s71, v68
  v_bitop3_b32 v8, v8, v69, s71 bitop3:0xf6
  v_bitop3_b32 v8, v8, v70, s71 bitop3:0xf6
  v_bitop3_b32 v8, v8, v71, s71 bitop3:0xf6
  v_and_b32 v8, s49, v8
  v_cmp_ne_u32 s[82:83], 0, v8
  s_or_b64 s[96:97], s[96:97], s[82:83]
B_ck_47:
  s_mov_b64 exec, s[84:85]
  s_cbranch_execz B_ck_48
  v_xor_b32 v8, s71, v72
  v_bitop3_b32 v8, v8, v73, s71 bitop3:0xf6
  v_bitop3_b32 v8, v8, v74, s71 bitop3:0xf6
  v_bitop3_b32 v8, v8, v75, s71 bitop3:0xf6
  v_and_b32 v8, s49, v8
  v_cmp_ne_u32 s[84:85], 0, v8
  s_or_b64 s[96:97], s[96:97], s[84:85]
B_ck_48:
  s_mov_b64 exec, s[86:87]
  s_cbranch_execz B_ck_49
  v_xor_b32 v8, s71, v76
  v_bitop3_b32 v8, v8, v77, s71 bitop3:0xf6
  v_bitop3_b32 v8, v8, v78, s71 bitop3:0xf6
  v_bitop3_b32 v8, v8, v79, s71 bitop3:0xf6
  v_and_b32 v8, s49, v8
  v_cmp_ne_u32 s[86:87], 0, v8
  s_or_b64 s[96:97], s[96:97], s[86:87]
B_ck_49:
  s_mov_b64 exec, s[88:89]
  s_cbranch_execz B_ck_50
  v_xor_b32 v8, s71, v80
  v_bitop3_b32 v8, v8, v81, s71 bitop3:0xf6
  v_bitop3_b32 v8, v8, v82, s71 bitop3:0xf6
  v_bitop3_b32 v8, v8, v83, s71 bitop3:0xf6
  v_and_b32 v8, s49, v8
  v_cmp_ne_u32 s[88:89], 0, v8
  s_or_b64 s[96:97], s[96:97], s[88:89]
B_ck_50:
  s_mov_b64 exec, s[90:91]
  s_cbranch_execz B_ck_51
  v_xor_b32 v8, s71, v84
  v_bitop3_b32 v8, v8, v85, s71 bitop3:0xf6
  v_bitop3_b32 v8, v8, v86, s71 bitop3:0xf6
  v_bitop3_b32 v8, v8, v87, s71 bitop3:0xf6
  v_and_b32 v8, s49, v8
  v_cmp_ne_u32 s[90:91], 0, v8
  s_or_b64 s[96:97], s[96:97], s[90:91]
B_ck_51:
  s_mov_b64 exec, -1
  s_or_b64 s[96:97], s[96:97], s[66:67]
  s_cbranch_scc0 B_done_30
  s_sub_u32 s68, s68, 1
  s_cmp_lg_u32 s68, 0
  s_cbranch_scc1 B_round_29
B_done_30:
  v_mov_b32 v8, v4
  s_nop 1
  v_max_f32_dpp v8, v8, v8 quad_perm:[1,0,3,2] row_mask:0xf bank_mask:0xf
  s_nop 1
  v_max_f32_dpp v8, v8, v8 quad_perm:[2,3,0,1] row_mask:0xf bank_mask:0xf
  s_nop 1
  v_max_f32_dpp v8, v8, v8 row_half_mirror row_mask:0xf bank_mask:0xf
  v_mov_b32 v9, v8
  s_nop 1
  v_permlane32_swap_b32 v8, v9
  s_nop 0
  v_max_f32 v8, v8, v9
  v_mov_b32 v9, v8
  s_nop 1
  v_permlane16_swap_b32 v8, v9
  s_nop 0
  v_max_f32 v8, v8, v9
  v_sub_f32 v8, v4, v8
  v_mul_f32 v8, s62, v8
  v_exp_f32 v8, v8
  s_nop 0
  v_mul_f32 v10, v8, v5
  v_mul_f32_dpp v16, v8, v56 row_newbcast:0 row_mask:0xf bank_mask:0xf
  v_mul_f32_dpp v17, v8, v57 row_newbcast:0 row_mask:0xf bank_mask:0xf
  v_mul_f32_dpp v18, v8, v58 row_newbcast:0 row_mask:0xf bank_mask:0xf
  v_mul_f32_dpp v19, v8, v59 row_newbcast:0 row_mask:0xf bank_mask:0xf
  v_add_f32_dpp v10, v10, v10 quad_perm:[1,0,3,2] row_mask:0xf bank_mask:0xf
  v_fmac_f32_dpp v16, v8, v60 row_newbcast:1 row_mask:0xf bank_mask:0xf
  v_fmac_f32_dpp v17, v8, v61 row_newbcast:1 row_mask:0xf bank_mask:0xf
  v_fmac_f32_dpp v18, v8, v62 row_newbcast:1 row_mask:0xf bank_mask:0xf
  v_fmac_f32_dpp v19, v8, v63 row_newbcast:1 row_mask:0xf bank_mask:0xf
  v_add_f32_dpp v10, v10, v10 quad_perm:[2,3,0,1] row_mask:0xf bank_mask:0xf
  v_fmac_f32_dpp v16, v8, v64 row_newbcast:2 row_mask:0xf bank_mask:0xf
  v_fmac_f32_dpp v17, v8, v65 row_newbcast:2 row_mask:0xf bank_mask:0xf
  v_fmac_f32_dpp v18, v8, v66 row_newbcast:2 row_mask:0xf bank_mask:0xf
  v_fmac_f32_dpp v19, v8, v67 row_newbcast:2 row_mask:0xf bank_mask:0xf
  v_add_f32_dpp v10, v10, v10 row_half_mirror row_mask:0xf bank_mask:0xf
  v_fmac_f32_dpp v16, v8, v68 row_newbcast:3 row_mask:0xf bank_mask:0xf
  v_fmac_f32_dpp v17, v8, v69 row_newbcast:3 row_mask:0xf bank_mask:0xf
  v_fmac_f32_dpp v18, v8, v70 row_newbcast:3 row_mask:0xf bank_mask:0xf
  v_fmac_f32_dpp v19, v8, v71 row_newbcast:3 row_mask:0xf bank_mask:0xf
  v_mov_b32 v11, v10
  v_fmac_f32_dpp v16, v8, v72 row_newbcast:4 row_mask:0xf bank_mask:0xf
  v_fmac_f32_dpp v17, v8, v73 row_newbcast:4 row_mask:0xf bank_mask:0xf
  v_fmac_f32_dpp v18, v8, v74 row_newbcast:4 row_mask:0xf bank_mask:0xf
  v_fmac_f32_dpp v19, v8, v75 row_newbcast:4 row_mask:0xf bank_mask:0xf
  v_permlane32_swap_b32 v10, v11
  v_fmac_f32_dpp v16, v8, v76 row_newbcast:5 row_mask:0xf bank_mask:0xf
  v_fmac_f32_dpp v17, v8, v77 row_newbcast:5 row_mask:0xf bank_mask:0xf
  v_fmac_f32_dpp v18, v8, v78 row_newbcast:5 row_mask:0xf bank_mask:0xf
  v_fmac_f32_dpp v19, v8, v79 row_newbcast:5 row_mask:0xf bank_mask:0xf
  v_add_f32 v10, v10, v11
  v_mov_b32 v11, v10
  v_fmac_f32_dpp v16, v8, v80 row_newbcast:6 row_mask:0xf bank_mask:0xf
  v_fmac_f32_dpp v17, v8, v81 row_newbcast:6 row_mask:0xf bank_mask:0xf
  v_fmac_f32_dpp v18, v8, v82 row_newbcast:6 row_mask:0xf bank_mask:0xf
  v_fmac_f32_dpp v19, v8, v83 row_newbcast:6 row_mask:0xf bank_mask:0xf
  v_permlane16_swap_b32 v10, v11
  v_fmac_f32_dpp v16, v8, v84 row_newbcast:7 row_mask:0xf bank_mask:0xf
  v_fmac_f32_dpp v17, v8, v85 row_newbcast:7 row_mask:0xf bank_mask:0xf
  v_fmac_f32_dpp v18, v8, v86 row_newbcast:7 row_mask:0xf bank_mask:0xf
  v_fmac_f32_dpp v19, v8, v87 row_newbcast:7 row_mask:0xf bank_mask:0xf
  v_add_f32 v10, v10, v11
  v_rcp_f32 v10, v10
  v_permlane32_swap_b32 v16, v18
  v_permlane32_swap_b32 v17, v19
  s_nop 0
  v_add_f32 v16, v16, v18
  v_add_f32 v17, v17, v19
  s_nop 1
  v_permlane16_swap_b32 v16, v17
  s_nop 0
  v_add_f32 v16, v16, v17
  v_mul_f32 v16, v16, v10
  v_cvt_pk_bf16_f32 v16, v16, v16
  ds_write_b32 v40, v16 offset:11264
  ds_read_b128 v[32:35], v41 offset:11264
  ds_read_b128 v[36:39], v41 offset:11280
  s_waitcnt vmcnt(0) lgkmcnt(1)
  v_and_b32 v20, v12, v32
  v_and_b32 v21, v13, v32
  v_and_b32 v22, v14, v32
  v_and_b32 v23, v15, v32
  v_and_b32 v24, v12, v33
  v_and_b32 v25, v13, v33
  v_and_b32 v26, v14, v33
  v_and_b32 v27, v15, v33
  v_mfma_f32_16x16x32_bf16 v[28:31], a[0:3], v[20:23], 0
  v_and_b32 v20, v12, v34
  v_and_b32 v21, v13, v34
  v_and_b32 v22, v14, v34
  v_and_b32 v23, v15, v34
  v_mfma_f32_16x16x32_bf16 v[28:31], a[4:7], v[24:27], v[28:31]
  v_and_b32 v24, v12, v35
  v_and_b32 v25, v13, v35
  v_and_b32 v26, v14, v35
  v_and_b32 v27, v15, v35
  v_mfma_f32_16x16x32_bf16 v[28:31], a[8:11], v[20:23], v[28:31]
  s_waitcnt lgkmcnt(0)
  v_and_b32 v20, v12, v36
  v_and_b32 v21, v13, v36
  v_and_b32 v22, v14, v36
  v_and_b32 v23, v15, v36
  v_mfma_f32_16x16x32_bf16 v[28:31], a[12:15], v[24:27], v[28:31]
  v_and_b32 v24, v12, v37
  v_and_b32 v25, v13, v37
  v_and_b32 v26, v14, v37
  v_and_b32 v27, v15, v37
  v_mfma_f32_16x16x32_bf16 v[28:31], a[16:19], v[20:23], v[28:31]
  v_and_b32 v20, v12, v38
  v_and_b32 v21, v13, v38
  v_and_b32 v22, v14, v38
  v_and_b32 v23, v15, v38
  v_mfma_f32_16x16x32_bf16 v[28:31], a[20:23], v[24:27], v[28:31]
  v_and_b32 v24, v12, v39
  v_and_b32 v25, v13, v39
  v_and_b32 v26, v14, v39
  v_and_b32 v27, v15, v39
  v_mfma_f32_16x16x32_bf16 v[28:31], a[24:27], v[20:23], v[28:31]
  s_nop 1
  v_mfma_f32_16x16x32_bf16 v[28:31], a[28:31], v[24:27], v[28:31]
  v_lshlrev_b32 v8, 2, v1
  s_mov_b32 exec_lo, 0xff00ff
  s_mov_b32 exec_hi, 0xff00ff00
  s_nop 4
  ds_write_b32 v42, v28 offset:13312
  ds_write_b32 v42, v29 offset:13344
  ds_write_b32 v42, v30 offset:13376
  ds_write_b32 v42, v31 offset:13408
  s_mov_b64 exec, -1
  s_waitcnt lgkmcnt(0)
  s_barrier
  s_cmp_lg_u32 s28, 0
  s_cbranch_scc1 L_end
  ds_read_b32 v32, v8 offset:13312
  ds_read_b32 v33, v8 offset:13568
  ds_read_b32 v34, v8 offset:13824
  ds_read_b32 v35, v8 offset:14080
  ds_read_b32 v36, v8 offset:14336
  ds_read_b32 v37, v8 offset:14592
  ds_read_b32 v38, v8 offset:14848
  ds_read_b32 v39, v8 offset:15104
  s_waitcnt lgkmcnt(0)
  v_pk_add_f32 v[32:33], v[32:33], v[34:35]
  v_pk_add_f32 v[36:37], v[36:37], v[38:39]
  v_pk_add_f32 v[32:33], v[32:33], v[36:37]
  v_add_f32 v32, v32, v33
  v_bfi_b32 v32, s49, v54, v32
  buffer_store_dword v32, v8, s[44:47], s94 offen sc1
  s_branch L_end
L_roleC:
  s_lshl_b32 s33, s28, 9
  v_lshl_add_u32 v2, v1, 3, s33
  v_lshrrev_b32 v4, 1, v2
  s_mov_b32 s56, s4
  s_mov_b32 s57, s5
  s_mov_b32 s58, 1024
  s_mov_b32 s59, 0x00020000
  buffer_load_dword v3, v4, s[56:59], 0 offen
  v_lshrrev_b32 v4, 1, v1
  v_lshlrev_b32 v4, 4, v4
  v_and_b32 v5, 1, v1
  v_lshl_add_u32 v4, v5, 14, v4
  s_add_u32 s33, s33, 32768
  v_add_u32 v2, s33, v4
  v_cmp_eq_u32 s[92:93], 1, v5
  v_and_b32 v4, 1, v1
  v_mov_b32 v5, 0xffff
  v_mov_b32 v6, s60
  v_cmp_eq_u32 vcc, 1, v4
  s_nop 1
  v_cndmask_b32 v5, v5, v6, vcc
  v_bfe_u32 v4, v1, 1, 2
  v_cmp_eq_u32 vcc, 0, v4
  s_nop 1
  v_cndmask_b32 v12, 0, v5, vcc
  v_cmp_eq_u32 vcc, 1, v4
  s_nop 1
  v_cndmask_b32 v13, 0, v5, vcc
  v_cmp_eq_u32 vcc, 2, v4
  s_nop 1
  v_cndmask_b32 v14, 0, v5, vcc
  v_cmp_eq_u32 vcc, 3, v4
  s_nop 1
  v_cndmask_b32 v15, 0, v5, vcc
  v_and_b32 v4, 3, v1
  v_mov_b32 v8, 0x0c0c0c0c
  v_mov_b32 v9, 0x0c0c0c0c
  v_mov_b32 v10, 0x0c0c0c0c
  v_mov_b32 v11, 0x0c0c0c0c
  v_cmp_eq_u32 vcc, 0, v4
  v_mov_b32 v5, 0xc0c0100
  v_mov_b32 v6, 0xc0c0302
  v_cndmask_b32 v8, v8, v5, vcc
  v_cndmask_b32 v9, v9, v6, vcc
  v_cmp_eq_u32 vcc, 1, v4
  v_mov_b32 v5, 0x1000c0c
  v_mov_b32 v6, 0x3020c0c
  v_cndmask_b32 v8, v8, v5, vcc
  v_cndmask_b32 v9, v9, v6, vcc
  v_cmp_eq_u32 vcc, 2, v4
  v_mov_b32 v5, 0xc0c0100
  v_mov_b32 v6, 0xc0c0302
  v_cndmask_b32 v10, v10, v5, vcc
  v_cndmask_b32 v11, v11, v6, vcc
  v_cmp_eq_u32 vcc, 3, v4
  v_mov_b32 v5, 0x1000c0c
  v_mov_b32 v6, 0x3020c0c
  v_cndmask_b32 v10, v10, v5, vcc
  v_cndmask_b32 v11, v11, v6, vcc
  s_lshl_b32 s34, s28, 4
  v_and_b32 v4, 3, v1
  v_lshlrev_b32 v4, 6, v4
  v_lshrrev_b32 v5, 4, v1
  v_lshl_add_u32 v4, v5, 2, v4
  v_add_u32 v44, s34, v4
  v_bfe_u32 v4, v1, 3, 1
  v_lshlrev_b32 v4, 11, v4
  v_lshl_add_u32 v4, v5, 9, v4
  v_and_b32 v6, 7, v1
  v_lshl_add_u32 v45, v6, 6, v4
  v_lshlrev_b32 v4, 7, v5
  v_lshl_add_u32 v46, v6, 4, v4
  s_lshl_b32 s94, s3, 11
  s_lshl_b32 s34, s28, 9
  s_add_u32 s94, s94, s34
  s_add_u32 s94, s94, 655360
  s_lshl_b32 s95, s28, 3
  v_mov_b32 v7, s95
  s_mov_b64 s[76:77], -1
  s_mov_b64 s[78:79], -1
  s_mov_b64 s[80:81], -1
  s_mov_b64 s[82:83], -1
  s_mov_b64 s[84:85], -1
  s_mov_b64 s[86:87], -1
  s_mov_b64 s[88:89], -1
  s_mov_b64 s[90:91], -1
  s_mov_b32 s68, 200000
C_round_52:
  s_mov_b64 exec, s[76:77]
  s_cbranch_execz C_sk_54
  s_mov_b32 s35, 0
  buffer_load_dwordx4 v[56:59], v2, s[44:47], s35 offen offset:0 sc1
C_sk_54:
  s_mov_b64 exec, s[78:79]
  s_cbranch_execz C_sk_55
  s_mov_b32 s35, 0
  buffer_load_dwordx4 v[60:63], v2, s[44:47], s35 offen offset:2048 sc1
C_sk_55:
  s_mov_b64 exec, s[80:81]
  s_cbranch_execz C_sk_56
  s_mov_b32 s35, 4096
  buffer_load_dwordx4 v[64:67], v2, s[44:47], s35 offen offset:0 sc1
C_sk_56:
  s_mov_b64 exec, s[82:83]
  s_cbranch_execz C_sk_57
  s_mov_b32 s35, 4096
  buffer_load_dwordx4 v[68:71], v2, s[44:47], s35 offen offset:2048 sc1
C_sk_57:
  s_mov_b64 exec, s[84:85]
  s_cbranch_execz C_sk_58
  s_mov_b32 s35, 8192
  buffer_load_dwordx4 v[72:75], v2, s[44:47], s35 offen offset:0 sc1
C_sk_58:
  s_mov_b64 exec, s[86:87]
  s_cbranch_execz C_sk_59
  s_mov_b32 s35, 8192
  buffer_load_dwordx4 v[76:79], v2, s[44:47], s35 offen offset:2048 sc1
C_sk_59:
  s_mov_b64 exec, s[88:89]
  s_cbranch_execz C_sk_60
  s_mov_b32 s35, 12288
  buffer_load_dwordx4 v[80:83], v2, s[44:47], s35 offen offset:0 sc1
C_sk_60:
  s_mov_b64 exec, s[90:91]
  s_cbranch_execz C_sk_61
  s_mov_b32 s35, 12288
  buffer_load_dwordx4 v[84:87], v2, s[44:47], s35 offen offset:2048 sc1
C_sk_61:
  s_mov_b64 s[96:97], 0
  s_waitcnt vmcnt(0)
  s_mov_b64 exec, s[76:77]
  s_cbranch_execz C_ck_62
  v_xor_b32 v4, s71, v56
  v_bitop3_b32 v4, v4, v57, s71 bitop3:0xf6
  v_bitop3_b32 v4, v4, v58, s71 bitop3:0xf6
  v_bitop3_b32 v4, v4, v59, s71 bitop3:0xf6
  v_and_b32 v4, s49, v4
  v_cmp_ne_u32 s[76:77], 0, v4
  s_or_b64 s[96:97], s[96:97], s[76:77]
C_ck_62:
  s_mov_b64 exec, s[78:79]
  s_cbranch_execz C_ck_63
  v_xor_b32 v4, s71, v60
  v_bitop3_b32 v4, v4, v61, s71 bitop3:0xf6
  v_bitop3_b32 v4, v4, v62, s71 bitop3:0xf6
  v_bitop3_b32 v4, v4, v63, s71 bitop3:0xf6
  v_and_b32 v4, s49, v4
  v_cmp_ne_u32 s[78:79], 0, v4
  s_or_b64 s[96:97], s[96:97], s[78:79]
C_ck_63:
  s_mov_b64 exec, s[80:81]
  s_cbranch_execz C_ck_64
  v_xor_b32 v4, s71, v64
  v_bitop3_b32 v4, v4, v65, s71 bitop3:0xf6
  v_bitop3_b32 v4, v4, v66, s71 bitop3:0xf6
  v_bitop3_b32 v4, v4, v67, s71 bitop3:0xf6
  v_and_b32 v4, s49, v4
  v_cmp_ne_u32 s[80:81], 0, v4
  s_or_b64 s[96:97], s[96:97], s[80:81]
C_ck_64:
  s_mov_b64 exec, s[82:83]
  s_cbranch_execz C_ck_65
  v_xor_b32 v4, s71, v68
  v_bitop3_b32 v4, v4, v69, s71 bitop3:0xf6
  v_bitop3_b32 v4, v4, v70, s71 bitop3:0xf6
  v_bitop3_b32 v4, v4, v71, s71 bitop3:0xf6
  v_and_b32 v4, s49, v4
  v_cmp_ne_u32 s[82:83], 0, v4
  s_or_b64 s[96:97], s[96:97], s[82:83]
C_ck_65:
  s_mov_b64 exec, s[84:85]
  s_cbranch_execz C_ck_66
  v_xor_b32 v4, s71, v72
  v_bitop3_b32 v4, v4, v73, s71 bitop3:0xf6
  v_bitop3_b32 v4, v4, v74, s71 bitop3:0xf6
  v_bitop3_b32 v4, v4, v75, s71 bitop3:0xf6
  v_and_b32 v4, s49, v4
  v_cmp_ne_u32 s[84:85], 0, v4
  s_or_b64 s[96:97], s[96:97], s[84:85]
C_ck_66:
  s_mov_b64 exec, s[86:87]
  s_cbranch_execz C_ck_67
  v_xor_b32 v4, s71, v76
  v_bitop3_b32 v4, v4, v77, s71 bitop3:0xf6
  v_bitop3_b32 v4, v4, v78, s71 bitop3:0xf6
  v_bitop3_b32 v4, v4, v79, s71 bitop3:0xf6
  v_and_b32 v4, s49, v4
  v_cmp_ne_u32 s[86:87], 0, v4
  s_or_b64 s[96:97], s[96:97], s[86:87]
C_ck_67:
  s_mov_b64 exec, s[88:89]
  s_cbranch_execz C_ck_68
  v_xor_b32 v4, s71, v80
  v_bitop3_b32 v4, v4, v81, s71 bitop3:0xf6
  v_bitop3_b32 v4, v4, v82, s71 bitop3:0xf6
  v_bitop3_b32 v4, v4, v83, s71 bitop3:0xf6
  v_and_b32 v4, s49, v4
  v_cmp_ne_u32 s[88:89], 0, v4
  s_or_b64 s[96:97], s[96:97], s[88:89]
C_ck_68:
  s_mov_b64 exec, s[90:91]
  s_cbranch_execz C_ck_69
  v_xor_b32 v4, s71, v84
  v_bitop3_b32 v4, v4, v85, s71 bitop3:0xf6
  v_bitop3_b32 v4, v4, v86, s71 bitop3:0xf6
  v_bitop3_b32 v4, v4, v87, s71 bitop3:0xf6
  v_and_b32 v4, s49, v4
  v_cmp_ne_u32 s[90:91], 0, v4
  s_or_b64 s[96:97], s[96:97], s[90:91]
C_ck_69:
  s_mov_b64 exec, -1
  s_cmp_eq_u64 s[96:97], 0
  s_cbranch_scc1 C_done_53
  s_sleep 1
  s_sub_u32 s68, s68, 1
  s_cmp_lg_u32 s68, 0
  s_cbranch_scc1 C_round_52
C_done_53:
  v_pk_add_f32 v[56:57], v[56:57], v[60:61]
  v_pk_add_f32 v[58:59], v[58:59], v[62:63]
  v_pk_add_f32 v[64:65], v[64:65], v[68:69]
  v_pk_add_f32 v[66:67], v[66:67], v[70:71]
  v_pk_add_f32 v[72:73], v[72:73], v[76:77]
  v_pk_add_f32 v[74:75], v[74:75], v[78:79]
  v_pk_add_f32 v[80:81], v[80:81], v[84:85]
  v_pk_add_f32 v[82:83], v[82:83], v[86:87]
  v_pk_add_f32 v[56:57], v[56:57], v[64:65]
  v_pk_add_f32 v[58:59], v[58:59], v[66:67]
  v_pk_add_f32 v[72:73], v[72:73], v[80:81]
  v_pk_add_f32 v[74:75], v[74:75], v[82:83]
  v_pk_add_f32 v[56:57], v[56:57], v[72:73]
  v_pk_add_f32 v[58:59], v[58:59], v[74:75]
  v_cndmask_b32 v60, v58, v56, s[92:93]
  v_cndmask_b32 v61, v59, v57, s[92:93]
  v_cndmask_b32 v56, v56, v58, s[92:93]
  v_cndmask_b32 v57, v57, v59, s[92:93]
  v_add_f32_dpp v56, v60, v56 quad_perm:[1,0,3,2] row_mask:0xf bank_mask:0xf
  v_add_f32_dpp v57, v61, v57 quad_perm:[1,0,3,2] row_mask:0xf bank_mask:0xf
  v_lshlrev_b32 v88, 16, v3
  v_and_b32 v89, s60, v3
  v_cvt_pk_bf16_f32 v4, v56, v57
  v_lshlrev_b32 v56, 16, v4
  v_and_b32 v57, s60, v4
  v_pk_add_f32 v[88:89], v[88:89], v[56:57]
  v_cvt_pk_bf16_f32 v4, v88, v89
  v_lshlrev_b32 v88, 16, v4
  v_and_b32 v89, s60, v4
  s_nop 0
  v_readfirstlane_b32 s33, v88
  s_nop 1
  v_subrev_f32 v4, s33, v88
  v_subrev_f32 v5, s33, v89
  v_add_f32 v92, v4, v5
  v_mul_f32 v93, v4, v4
  v_fmac_f32 v93, v5, v5
  s_nop 1
  v_add_f32_dpp v92, v92, v92 quad_perm:[1,0,3,2] row_mask:0xf bank_mask:0xf
  v_add_f32_dpp v93, v93, v93 quad_perm:[1,0,3,2] row_mask:0xf bank_mask:0xf
  s_nop 1
  v_add_f32_dpp v92, v92, v92 quad_perm:[2,3,0,1] row_mask:0xf bank_mask:0xf
  v_add_f32_dpp v93, v93, v93 quad_perm:[2,3,0,1] row_mask:0xf bank_mask:0xf
  s_nop 1
  v_add_f32_dpp v92, v92, v92 row_half_mirror row_mask:0xf bank_mask:0xf
  v_add_f32_dpp v93, v93, v93 row_half_mirror row_mask:0xf bank_mask:0xf
  s_nop 1
  v_add_f32_dpp v92, v92, v92 row_mirror row_mask:0xf bank_mask:0xf
  v_add_f32_dpp v93, v93, v93 row_mirror row_mask:0xf bank_mask:0xf
  s_nop 1
  v_permlane32_swap_b32 v92, v93
  s_nop 0
  v_add_f32 v92, v92, v93
  v_mov_b32 v4, v92
  s_nop 1
  v_permlane16_swap_b32 v92, v4
  s_nop 0
  v_add_f32 v92, v92, v4
  s_nop 0
  v_readlane_b32 s34, v92, 0
  v_readlane_b32 s35, v92, 32
  v_mov_b32 v4, 0x3c000000
  s_nop 0
  v_mul_f32 v4, s34, v4
  v_mov_b32 v93, s35
  v_add_f32 v92, s33, v4
  v_fma_f32 v93, -v4, s34, v93
  s_mov_b64 exec, 1
  ds_write_b64 v7, v[92:93] offset:13312
  s_mov_b64 exec, -1
  s_waitcnt lgkmcnt(0)
  s_barrier
  ds_read_b128 v[92:95], v50 offset:13312
  ds_read_b128 v[96:99], v50 offset:13328
  s_waitcnt lgkmcnt(0)
  v_pk_add_f32 v[100:101], v[92:93], v[94:95]
  v_pk_add_f32 v[102:103], v[96:97], v[98:99]
  v_pk_add_f32 v[100:101], v[100:101], v[102:103]
  v_mul_f32 v4, 0.25, v100
  v_sub_f32 v92, v92, v4
  v_sub_f32 v94, v94, v4
  v_sub_f32 v96, v96, v4
  v_sub_f32 v98, v98, v4
  v_mul_f32 v5, v92, v92
  v_fmac_f32 v5, v94, v94
  v_fmac_f32 v5, v96, v96
  v_fmac_f32 v5, v98, v98
  v_mul_f32 v6, 0x3b000000, v101
  v_fmac_f32 v6, 0.25, v5
  v_cvt_pk_bf16_f32 v5, v4, v6
  v_lshlrev_b32 v4, 16, v5
  v_and_b32 v6, s60, v5
  v_add_f32 v6, 0x3727c5ac, v6
  v_sub_f32 v88, v88, v4
  v_cvt_pk_bf16_f32 v6, v6, v6
  v_and_b32 v6, s60, v6
  v_sub_f32 v89, v89, v4
  v_sqrt_f32 v6, v6
  v_cvt_pk_bf16_f32 v5, v88, v89
  v_cvt_pk_bf16_f32 v6, v6, v6
  v_and_b32 v6, s60, v6
  v_lshlrev_b32 v88, 16, v5
  v_and_b32 v89, s60, v5
  v_rcp_f32 v7, v6
  s_nop 0
  v_mul_f32 v92, v88, v7
  v_mul_f32 v93, v89, v7
  v_fma_f32 v88, -v92, v6, v88
  v_fma_f32 v89, -v93, v6, v89
  v_fma_f32 v88, v88, v7, v92
  v_fma_f32 v89, v89, v7, v93
  v_cvt_pk_bf16_f32 v4, v88, v89
  s_nop 1
  v_mov_b32_dpp v16, v4 quad_perm:[0,0,0,0] row_mask:0xf bank_mask:0xf
  v_mov_b32_dpp v17, v4 quad_perm:[1,1,1,1] row_mask:0xf bank_mask:0xf
  v_mov_b32_dpp v18, v4 quad_perm:[2,2,2,2] row_mask:0xf bank_mask:0xf
  v_mov_b32_dpp v19, v4 quad_perm:[3,3,3,3] row_mask:0xf bank_mask:0xf
  v_perm_b32 v20, v16, v16, v8
  v_perm_b32 v21, v16, v16, v10
  v_perm_b32 v22, v16, v16, v9
  v_perm_b32 v23, v16, v16, v11
  v_mfma_f32_16x16x16_bf16 v[28:31], a[0:1], v[20:21], 0
  v_mfma_f32_16x16x16_bf16 v[32:35], a[2:3], v[20:21], 0
  v_mfma_f32_16x16x16_bf16 v[36:39], a[32:33], v[20:21], 0
  v_mfma_f32_16x16x16_bf16 v[40:43], a[34:35], v[20:21], 0
  v_perm_b32 v20, v17, v17, v8
  v_perm_b32 v21, v17, v17, v10
  v_mfma_f32_16x16x16_bf16 v[28:31], a[4:5], v[22:23], v[28:31]
  v_mfma_f32_16x16x16_bf16 v[32:35], a[6:7], v[22:23], v[32:35]
  v_mfma_f32_16x16x16_bf16 v[36:39], a[36:37], v[22:23], v[36:39]
  v_mfma_f32_16x16x16_bf16 v[40:43], a[38:39], v[22:23], v[40:43]
  v_perm_b32 v22, v17, v17, v9
  v_perm_b32 v23, v17, v17, v11
  v_mfma_f32_16x16x16_bf16 v[28:31], a[8:9], v[20:21], v[28:31]
  v_mfma_f32_16x16x16_bf16 v[32:35], a[10:11], v[20:21], v[32:35]
  v_mfma_f32_16x16x16_bf16 v[36:39], a[40:41], v[20:21], v[36:39]
  v_mfma_f32_16x16x16_bf16 v[40:43], a[42:43], v[20:21], v[40:43]
  v_perm_b32 v20, v18, v18, v8
  v_perm_b32 v21, v18, v18, v10
  v_mfma_f32_16x16x16_bf16 v[28:31], a[12:13], v[22:23], v[28:31]
  v_mfma_f32_16x16x16_bf16 v[32:35], a[14:15], v[22:23], v[32:35]
  v_mfma_f32_16x16x16_bf16 v[36:39], a[44:45], v[22:23], v[36:39]
  v_mfma_f32_16x16x16_bf16 v[40:43], a[46:47], v[22:23], v[40:43]
  v_perm_b32 v22, v18, v18, v9
  v_perm_b32 v23, v18, v18, v11
  v_mfma_f32_16x16x16_bf16 v[28:31], a[16:17], v[20:21], v[28:31]
  v_mfma_f32_16x16x16_bf16 v[32:35], a[18:19], v[20:21], v[32:35]
  v_mfma_f32_16x16x16_bf16 v[36:39], a[48:49], v[20:21], v[36:39]
  v_mfma_f32_16x16x16_bf16 v[40:43], a[50:51], v[20:21], v[40:43]
  v_perm_b32 v20, v19, v19, v8
  v_perm_b32 v21, v19, v19, v10
  v_mfma_f32_16x16x16_bf16 v[28:31], a[20:21], v[22:23], v[28:31]
  v_mfma_f32_16x16x16_bf16 v[32:35], a[22:23], v[22:23], v[32:35]
  v_mfma_f32_16x16x16_bf16 v[36:39], a[52:53], v[22:23], v[36:39]
  v_mfma_f32_16x16x16_bf16 v[40:43], a[54:55], v[22:23], v[40:43]
  v_perm_b32 v22, v19, v19, v9
  v_perm_b32 v23, v19, v19, v11
  v_mfma_f32_16x16x16_bf16 v[28:31], a[24:25], v[20:21], v[28:31]
  v_mfma_f32_16x16x16_bf16 v[32:35], a[26:27], v[20:21], v[32:35]
  v_mfma_f32_16x16x16_bf16 v[36:39], a[56:57], v[20:21], v[36:39]
  v_mfma_f32_16x16x16_bf16 v[40:43], a[58:59], v[20:21], v[40:43]
  s_nop 1
  v_mfma_f32_16x16x16_bf16 v[28:31], a[28:29], v[22:23], v[28:31]
  v_mfma_f32_16x16x16_bf16 v[32:35], a[30:31], v[22:23], v[32:35]
  v_mfma_f32_16x16x16_bf16 v[36:39], a[60:61], v[22:23], v[36:39]
  v_mfma_f32_16x16x16_bf16 v[40:43], a[62:63], v[22:23], v[40:43]
  s_mov_b32 exec_lo, 0xf0000f
  s_mov_b32 exec_hi, 0xf0000f00
  s_nop 2
  ds_write_b32 v44, v28 offset:17408
  ds_write_b32 v44, v29 offset:17920
  ds_write_b32 v44, v30 offset:18432
  ds_write_b32 v44, v31 offset:18944
  ds_write_b32 v44, v32 offset:17664
  ds_write_b32 v44, v33 offset:18176
  ds_write_b32 v44, v34 offset:18688
  ds_write_b32 v44, v35 offset:19200
  ds_write_b32 v44, v36 offset:19456
  ds_write_b32 v44, v37 offset:19968
  ds_write_b32 v44, v38 offset:20480
  ds_write_b32 v44, v39 offset:20992
  ds_write_b32 v44, v40 offset:19712
  ds_write_b32 v44, v41 offset:20224
  ds_write_b32 v44, v42 offset:20736
  ds_write_b32 v44, v43 offset:21248
  s_mov_b64 exec, -1
  s_waitcnt lgkmcnt(0)
  s_barrier
  ds_read_b128 v[92:95], v45 offset:17408
  ds_read_b128 v[96:99], v45 offset:17424
  ds_read_b128 v[100:103], v45 offset:17440
  ds_read_b128 v[104:107], v45 offset:17456
  s_waitcnt lgkmcnt(2)
  v_pk_add_f32 v[92:93], v[92:93], v[94:95]
  v_pk_add_f32 v[96:97], v[96:97], v[98:99]
  v_pk_add_f32 v[92:93], v[92:93], v[96:97]
  s_waitcnt lgkmcnt(0)
  v_pk_add_f32 v[100:101], v[100:101], v[102:103]
  v_pk_add_f32 v[104:105], v[104:105], v[106:107]
  v_pk_add_f32 v[100:101], v[100:101], v[104:105]
  v_pk_add_f32 v[92:93], v[92:93], v[100:101]
  v_add_f32 v92, v92, v93
  v_cvt_pk_bf16_f32 v92, v92, v92
  v_and_b32 v92, s60, v92
  v_mul_f32 v4, s63, v92
  v_exp_f32 v4, v4
  v_mov_b32_dpp v5, v92 row_ror:8 row_mask:0xf bank_mask:0xf
  v_add_f32 v4, 1.0, v4
  v_rcp_f32 v6, v4
  s_nop 0
  v_cvt_pk_bf16_f32 v6, v6, v6
  v_and_b32 v6, s60, v6
  v_mul_f32 v6, v6, v5
  v_cvt_pk_bf16_f32 v6, v6, v6
  s_nop 1
  v_and_b32_dpp v20, v6, v12 row_newbcast:0 row_mask:0xf bank_mask:0xf
  v_and_b32_dpp v21, v6, v13 row_newbcast:0 row_mask:0xf bank_mask:0xf
  v_and_b32_dpp v22, v6, v14 row_newbcast:0 row_mask:0xf bank_mask:0xf
  v_and_b32_dpp v23, v6, v15 row_newbcast:0 row_mask:0xf bank_mask:0xf
  v_and_b32_dpp v24, v6, v12 row_newbcast:1 row_mask:0xf bank_mask:0xf
  v_and_b32_dpp v25, v6, v13 row_newbcast:1 row_mask:0xf bank_mask:0xf
  v_and_b32_dpp v26, v6, v14 row_newbcast:1 row_mask:0xf bank_mask:0xf
  v_and_b32_dpp v27, v6, v15 row_newbcast:1 row_mask:0xf bank_mask:0xf
  v_mfma_f32_16x16x32_bf16 v[28:31], a[64:67], v[20:23], 0
  v_and_b32_dpp v20, v6, v12 row_newbcast:2 row_mask:0xf bank_mask:0xf
  v_and_b32_dpp v21, v6, v13 row_newbcast:2 row_mask:0xf bank_mask:0xf
  v_and_b32_dpp v22, v6, v14 row_newbcast:2 row_mask:0xf bank_mask:0xf
  v_and_b32_dpp v23, v6, v15 row_newbcast:2 row_mask:0xf bank_mask:0xf
  v_mfma_f32_16x16x32_bf16 v[28:31], a[68:71], v[24:27], v[28:31]
  v_and_b32_dpp v24, v6, v12 row_newbcast:3 row_mask:0xf bank_mask:0xf
  v_and_b32_dpp v25, v6, v13 row_newbcast:3 row_mask:0xf bank_mask:0xf
  v_and_b32_dpp v26, v6, v14 row_newbcast:3 row_mask:0xf bank_mask:0xf
  v_and_b32_dpp v27, v6, v15 row_newbcast:3 row_mask:0xf bank_mask:0xf
  v_mfma_f32_16x16x32_bf16 v[28:31], a[72:75], v[20:23], v[28:31]
  v_and_b32_dpp v20, v6, v12 row_newbcast:4 row_mask:0xf bank_mask:0xf
  v_and_b32_dpp v21, v6, v13 row_newbcast:4 row_mask:0xf bank_mask:0xf
  v_and_b32_dpp v22, v6, v14 row_newbcast:4 row_mask:0xf bank_mask:0xf
  v_and_b32_dpp v23, v6, v15 row_newbcast:4 row_mask:0xf bank_mask:0xf
  v_mfma_f32_16x16x32_bf16 v[28:31], a[76:79], v[24:27], v[28:31]
  v_and_b32_dpp v24, v6, v12 row_newbcast:5 row_mask:0xf bank_mask:0xf
  v_and_b32_dpp v25, v6, v13 row_newbcast:5 row_mask:0xf bank_mask:0xf
  v_and_b32_dpp v26, v6, v14 row_newbcast:5 row_mask:0xf bank_mask:0xf
  v_and_b32_dpp v27, v6, v15 row_newbcast:5 row_mask:0xf bank_mask:0xf
  v_mfma_f32_16x16x32_bf16 v[28:31], a[80:83], v[20:23], v[28:31]
  v_and_b32_dpp v20, v6, v12 row_newbcast:6 row_mask:0xf bank_mask:0xf
  v_and_b32_dpp v21, v6, v13 row_newbcast:6 row_mask:0xf bank_mask:0xf
  v_and_b32_dpp v22, v6, v14 row_newbcast:6 row_mask:0xf bank_mask:0xf
  v_and_b32_dpp v23, v6, v15 row_newbcast:6 row_mask:0xf bank_mask:0xf
  v_mfma_f32_16x16x32_bf16 v[28:31], a[84:87], v[24:27], v[28:31]
  v_and_b32_dpp v24, v6, v12 row_newbcast:7 row_mask:0xf bank_mask:0xf
  v_and_b32_dpp v25, v6, v13 row_newbcast:7 row_mask:0xf bank_mask:0xf
  v_and_b32_dpp v26, v6, v14 row_newbcast:7 row_mask:0xf bank_mask:0xf
  v_and_b32_dpp v27, v6, v15 row_newbcast:7 row_mask:0xf bank_mask:0xf
  v_mfma_f32_16x16x32_bf16 v[28:31], a[88:91], v[20:23], v[28:31]
  s_nop 1
  v_mfma_f32_16x16x32_bf16 v[28:31], a[92:95], v[24:27], v[28:31]
  s_mov_b32 exec_lo, 0xff00ff
  s_mov_b32 exec_hi, 0xff00ff
  s_nop 5
  v_bfi_b32 v28, s49, v54, v28
  v_bfi_b32 v29, s49, v54, v29
  v_bfi_b32 v30, s49, v54, v30
  v_bfi_b32 v31, s49, v54, v31
  buffer_store_dwordx4 v[28:31], v46, s[44:47], s94 offen sc1
  s_mov_b64 exec, -1
  s_branch L_end
L_roleE:
  s_lshl_b32 s33, s3, 2
  s_add_u32 s33, s33, s28
  s_lshr_b32 s34, s33, 2
  s_lshl_b32 s34, s34, 5
  s_and_b32 s35, s33, 3
  s_lshl_b32 s35, s35, 1
  s_add_u32 s34, s34, s35
  v_lshrrev_b32 v6, 4, v1
  v_lshlrev_b32 v6, 3, v6
  v_add_u32 v6, s34, v6
  v_lshlrev_b32 v4, 1, v6
  s_mov_b32 s56, s4
  s_mov_b32 s57, s5
  s_mov_b32 s58, 1024
  s_mov_b32 s59, 0x00020000
  buffer_load_dword v66, v4, s[56:59], 0 offen
  v_and_b32 v7, 15, v1
  v_lshlrev_b32 v7, 11, v7
  v_lshl_add_u32 v3, v6, 2, v7
  v_add_u32 v3, 32768, v3
  s_lshl_b32 s35, s33, 5
  s_add_u32 s35, s35, 655360
  v_lshlrev_b32 v2, 11, v1
  v_add_u32 v2, s35, v2
  s_mov_b32 s52, s22
  s_mov_b32 s53, s23
  s_mov_b32 s54, 1024
  s_mov_b32 s55, 0x00020000
  v_mov_b32 v56, 0
  v_mov_b32 v57, 0
  v_mov_b32 v58, 0
  v_mov_b32 v59, 0
  v_mov_b32 v60, 0
  v_mov_b32 v61, 0
  v_mov_b32 v62, 0
  v_mov_b32 v63, 0
  s_mov_b32 s68, 200000
EH_70:
  buffer_load_dwordx2 v[64:65], v3, s[44:47], 0 offen sc1
  s_waitcnt vmcnt(0)
  v_xor_b32 v6, s71, v64
  v_bitop3_b32 v6, v6, v65, s71 bitop3:0xf6
  v_and_b32 v6, s49, v6
  v_cmp_ne_u32 vcc, 0, v6
  s_sub_u32 s68, s68, 1
  s_cmp_eq_u32 s68, 0
  s_cbranch_scc1 EH_done_71
  s_cbranch_vccz EH_done_71
  s_sleep 4
  s_branch EH_70
EH_done_71:
  s_nop 1
  v_add_f32_dpp v64, v64, v64 quad_perm:[1,0,3,2] row_mask:0xf bank_mask:0xf
  v_add_f32_dpp v65, v65, v65 quad_perm:[1,0,3,2] row_mask:0xf bank_mask:0xf
  s_nop 1
  v_add_f32_dpp v64, v64, v64 quad_perm:[2,3,0,1] row_mask:0xf bank_mask:0xf
  v_add_f32_dpp v65, v65, v65 quad_perm:[2,3,0,1] row_mask:0xf bank_mask:0xf
  s_nop 1
  v_add_f32_dpp v64, v64, v64 row_half_mirror row_mask:0xf bank_mask:0xf
  v_add_f32_dpp v65, v65, v65 row_half_mirror row_mask:0xf bank_mask:0xf
  s_nop 1
  v_add_f32_dpp v64, v64, v64 row_mirror row_mask:0xf bank_mask:0xf
  v_add_f32_dpp v65, v65, v65 row_mirror row_mask:0xf bank_mask:0xf
  v_cvt_pk_bf16_f32 v6, v64, v65
  v_lshlrev_b32 v64, 16, v6
  v_and_b32 v65, s60, v6
  v_lshlrev_b32 v6, 16, v66
  v_and_b32 v7, s60, v66
  v_add_f32 v64, v64, v6
  v_add_f32 v65, v65, v7
  v_cvt_pk_bf16_f32 v6, v64, v65
  v_lshlrev_b32 v64, 16, v6
  v_and_b32 v65, s60, v6
  s_mov_b32 exec_lo, 0xffffffff
  s_mov_b32 exec_hi, 0xffffff
  s_mov_b32 s68, 200000
EO_72:
  buffer_load_dwordx4 v[56:59], v2, s[44:47], 0 offen sc1
  buffer_load_dwordx4 v[60:63], v2, s[44:47], 0 offen offset:16 sc1
  s_waitcnt vmcnt(0)
  v_xor_b32 v6, s71, v56
  v_bitop3_b32 v6, v6, v57, s71 bitop3:0xf6
  v_bitop3_b32 v6, v6, v58, s71 bitop3:0xf6
  v_bitop3_b32 v6, v6, v59, s71 bitop3:0xf6
  v_bitop3_b32 v6, v6, v60, s71 bitop3:0xf6
  v_bitop3_b32 v6, v6, v61, s71 bitop3:0xf6
  v_bitop3_b32 v6, v6, v62, s71 bitop3:0xf6
  v_bitop3_b32 v6, v6, v63, s71 bitop3:0xf6
  v_and_b32 v6, s49, v6
  v_cmp_ne_u32 vcc, 0, v6
  s_sub_u32 s68, s68, 1
  s_cmp_eq_u32 s68, 0
  s_cbranch_scc1 EO_done_73
  s_mov_b64 exec, vcc
  s_cbranch_vccnz EO_72
EO_done_73:
  s_mov_b64 exec, -1
  v_permlane32_swap_b32 v56, v58
  v_permlane32_swap_b32 v57, v59
  v_permlane32_swap_b32 v60, v62
  v_permlane32_swap_b32 v61, v63
  s_nop 0
  v_add_f32 v56, v56, v58
  v_add_f32 v57, v57, v59
  v_add_f32 v60, v60, v62
  v_add_f32 v61, v61, v63
  s_nop 1
  v_permlane16_swap_b32 v56, v57
  v_permlane16_swap_b32 v60, v61
  s_nop 0
  v_add_f32 v56, v56, v57
  v_add_f32 v60, v60, v61
  s_nop 1
  v_add_f32_dpp v56, v56, v56 quad_perm:[1,0,3,2] row_mask:0xf bank_mask:0xf
  v_add_f32_dpp v60, v60, v60 quad_perm:[1,0,3,2] row_mask:0xf bank_mask:0xf
  s_nop 1
  v_add_f32_dpp v56, v56, v56 quad_perm:[2,3,0,1] row_mask:0xf bank_mask:0xf
  v_add_f32_dpp v60, v60, v60 quad_perm:[2,3,0,1] row_mask:0xf bank_mask:0xf
  s_nop 1
  v_add_f32_dpp v56, v56, v56 row_half_mirror row_mask:0xf bank_mask:0xf
  v_add_f32_dpp v60, v60, v60 row_half_mirror row_mask:0xf bank_mask:0xf
  s_nop 1
  v_add_f32_dpp v56, v56, v56 row_mirror row_mask:0xf bank_mask:0xf
  v_add_f32_dpp v60, v60, v60 row_mirror row_mask:0xf bank_mask:0xf
  v_cvt_pk_bf16_f32 v6, v56, v60
  v_lshlrev_b32 v56, 16, v6
  v_and_b32 v60, s60, v6
  v_add_f32 v56, v56, v64
  v_add_f32 v60, v60, v65
  v_cvt_pk_bf16_f32 v6, v56, v60
  s_mov_b32 exec_lo, 0x10001
  s_mov_b32 exec_hi, 0x10001
  buffer_store_dword v6, v4, s[52:55], 0 offen
  s_mov_b64 exec, -1
  s_cmp_lg_u32 s33, 0
  s_cbranch_scc1 L_end
  s_add_u32 s29, s29, 1
  v_mov_b32 v6, s29
  v_mov_b32 v7, 0
  s_mov_b64 exec, 1
  buffer_store_dword v6, v7, s[44:47], 0 offen
  s_branch L_end
L_end:
  s_endpgm
.section .rodata,"a"
.p2align 6
.amdhsa_kernel sequential_preLN__gqa_block_cached__glu_gated_glu__decode_kernel
  .amdhsa_next_free_vgpr 336
  .amdhsa_next_free_sgpr 102
  .amdhsa_accum_offset 144
  .amdhsa_group_segment_fixed_size 0
  .amdhsa_kernarg_size 96
  .amdhsa_user_sgpr_count 2
  .amdhsa_user_sgpr_kernarg_segment_ptr 1
  .amdhsa_system_sgpr_workgroup_id_x 1
  .amdhsa_float_denorm_mode_32 3
.end_amdhsa_kernel
```
